```python
import torch

def _softmax(x, axis=-1):
    return torch.softmax(x, dim=axis)

def _gelu(x):
    return torch.nn.functional.gelu(x, approximate='tanh')

def _silu(x):
    return torch.nn.functional.silu(x)

def _sigmoid(x):
    return torch.sigmoid(x)

def _layernorm(x, axis=-1, eps=1e-05):
    m = x.mean(dim=axis, keepdim=True)
    v = x.var(dim=axis, keepdim=True, unbiased=False)
    return (x - m) / torch.sqrt(v + eps)

def _scatter_add(tgt, idx, src, axis=0):
    return tgt.clone().index_add_(axis, idx, src)

def _segment_sum(src, seg, n):
    out = torch.zeros((n,) + src.shape[1:], dtype=src.dtype)
    return out.index_add_(0, seg, src)

def _pad(x, pw):
    flat = tuple((v for pair in reversed(pw) for v in pair))
    return torch.nn.functional.pad(x, flat)
kernel_name = 'adaLN_cond__sliding_block_cached__swiglu_ffn__decode'

def setup_inputs():

    _w = lambda a: (lambda t: t.to(torch.bfloat16) if t.is_floating_point() else t)(torch.as_tensor(a))

    def _A_setup():
        B, Sq, D = (4, 1, 512)
        Hq, Hkv, Sk, Dh = (32, 8, 4096, 128)
        assert Hq % Hkv == 0, (Hq, Hkv)
        return {'x': _w((lambda *s: torch.randn(*s, dtype=torch.bfloat16) * 0.05)(B, Sq, D)), 'k_cache': _w((lambda *s: torch.randn(*s, dtype=torch.bfloat16) * 3.2)(B, Hkv, Sk, Dh)), 'v_cache': _w((lambda *s: torch.randn(*s, dtype=torch.bfloat16) * 0.4)(B, Hkv, Sk, Dh)), 'wq': _w((lambda *s: torch.randn(*s, dtype=torch.bfloat16) * 3.2)(D, Hq * Dh) * D ** (-0.5)), 'wo': _w((lambda *s: torch.randn(*s, dtype=torch.bfloat16) * 0.4)(Hq * Dh, D) * (Hq * Dh) ** (-0.5))}
    _A_in = _A_setup()

    def _B_setup():
        B, S, D, F = (4, 1, 512, 1792)
        return {'x': _w((lambda *s: torch.randn(*s, dtype=torch.bfloat16) * 0.05)(B, S, D)), 'w_gate': _w((lambda *s: torch.randn(*s, dtype=torch.bfloat16) * 0.05)(D, F)), 'w_up': _w((lambda *s: torch.randn(*s, dtype=torch.bfloat16) * 0.05)(D, F)), 'w_down': _w((lambda *s: torch.randn(*s, dtype=torch.bfloat16) * 0.05)(F, D))}
    _B_in = _B_setup()
    return {'A_x': _A_in['x'], 'A_k_cache': _A_in['k_cache'], 'A_v_cache': _A_in['v_cache'], 'A_wq': _A_in['wq'], 'A_wo': _A_in['wo'], 'B_x': _B_in['x'], 'B_w_gate': _B_in['w_gate'], 'B_w_up': _B_in['w_up'], 'B_w_down': _B_in['w_down'], 'c': _w((lambda *s: torch.randn(*s, dtype=torch.bfloat16) * 0.1)(4, 512) * 8.0), 'w_mod': _w((lambda *s: torch.randn(*s, dtype=torch.bfloat16) * 0.1)(512, 6 * 512) * 512 ** (-0.5) * 8.0)}

def reference(A_x, A_k_cache, A_v_cache, A_wq, A_wo, B_x, B_w_gate, B_w_up, B_w_down, c, w_mod):

    def _A_ref(x, k_cache, v_cache, wq, wo):
        B, Sq, D = x.shape
        Hq, Dh = (32, 128)
        Hkv, Sk = (k_cache.shape[1], k_cache.shape[2])
        W = min(4096, max(256, Sk // 4))
        rep = Hq // Hkv
        q = (lambda x, *d: x.permute(*d))((x @ wq).reshape(B, Sq, Hq, Dh), 0, 2, 1, 3)
        k = (lambda x, n, axis: torch.repeat_interleave(x, n, dim=axis))(k_cache[:, :, Sk - W:, :], rep, axis=1)
        v = (lambda x, n, axis: torch.repeat_interleave(x, n, dim=axis))(v_cache[:, :, Sk - W:, :], rep, axis=1)
        scores = torch.einsum('bhqd,bhkd->bhqk', q, k) * Dh ** (-0.5)
        p = _softmax(scores, axis=-1)
        o = torch.einsum('bhqk,bhkd->bhqd', p, v)
        return (lambda x, *d: x.permute(*d))(o, 0, 2, 1, 3).reshape(B, Sq, Hq * Dh) @ wo

    def _B_ref(x, w_gate, w_up, w_down):
        g = _silu(x @ w_gate)
        u = x @ w_up
        return g * u @ w_down
    x = A_x
    mod = (_silu(c) @ w_mod).reshape(c.shape[0], 6, 1, -1)
    sa, ca, ga, sb, cb, gb = (mod[:, 0].clone(), mod[:, 1].clone(), mod[:, 2].clone(), mod[:, 3].clone(), mod[:, 4].clone(), mod[:, 5].clone())
    h = _layernorm(x, axis=-1) * (1 + ca) + sa
    x = x + ga * _A_ref(h, A_k_cache, A_v_cache, A_wq, A_wo)
    h = _layernorm(x, axis=-1) * (1 + cb) + sb
    x = x + gb * _B_ref(h, B_w_gate, B_w_up, B_w_down)
    return x
```

```asm
; @launch grid=(256,1,1) block=(512,1,1) lds=147456
.amdgcn_target "amdgcn-amd-amdhsa--gfx950"
.text
.globl adaLN_cond__sliding_block_cached__swiglu_ffn__decode_kernel
.p2align 8
.type adaLN_cond__sliding_block_cached__swiglu_ffn__decode_kernel,@function
adaLN_cond__sliding_block_cached__swiglu_ffn__decode_kernel:
  s_load_dwordx16 s[8:23], s[0:1], 0
  s_load_dwordx8 s[24:31], s[0:1], 64
  s_load_dwordx4 s[32:35], s[0:1], 96
  s_getpc_b64 s[4:5]
L_pc:
  v_lshlrev_b32 v15, 7, v0
  v_min_u32 v15, L_end-L_pc, v15
  global_load_dword v31, v15, s[4:5]
  v_lshrrev_b32 v6, 6, v0
  v_and_b32 v1, 63, v0
  s_and_b32 s37, s2, 7
  v_readfirstlane_b32 s39, v6
  s_lshr_b32 s38, s2, 3
  v_and_b32 v2, 15, v0
  v_lshrrev_b32 v3, 4, v1
  s_cmp_ge_u32 s39, 6
  s_cbranch_scc1 L_w67
L_disp:
  s_cmp_ge_u32 s38, 16
  s_cbranch_scc1 L_roleA
  s_cmp_ge_u32 s38, 8
  s_cbranch_scc1 L_roleX
  v_lshrrev_b32 v6, 3, v1
  v_mul_u32_u24 v4, 6144, v6
  v_and_b32 v6, 2, v6
  v_xor_b32 v6, v6, v1
  v_and_b32 v6, 7, v6
  v_lshl_add_u32 v4, v6, 4, v4
  v_xor_b32 v5, 64, v4
  s_lshl_b32 m0, s39, 13
  v_lshrrev_b32 v6, 2, v2
  v_lshlrev_b32 v6, 10, v6
  v_lshl_add_u32 v6, v3, 5, v6
  v_and_b32 v7, 3, v2
  v_lshl_add_u32 v6, v7, 3, v6
  s_lshl_b32 s40, s38, 7
  v_add_u32 v6, s40, v6
  s_mul_i32 s40, s38, 393216
  s_mov_b32 s50, 3145728
  s_mov_b32 s51, 0x20000
  s_movk_i32 s62, 1024
  s_mov_b32 s63, 49152
  s_cmp_ge_u32 s39, 2
  s_cbranch_scc1 L_Yrest
  s_xor_b32 s41, s37, 7
  s_lshl_b32 s41, s41, 7
  s_add_u32 s40, s40, s41
  s_lshl_b32 s41, s39, 10
  s_add_u32 s40, s40, s41
  s_waitcnt lgkmcnt(0)
  s_mov_b32 s48, s28
  s_mov_b32 s49, s29
  global_load_dwordx2 v[96:97], v6, s[26:27]
  buffer_load_dwordx4 v4, s[48:51], s40 offen nt lds
  s_add_u32 m0, m0, s62
  s_add_u32 s40, s40, s63
  buffer_load_dwordx4 v4, s[48:51], s40 offen nt lds
  s_add_u32 m0, m0, s62
  s_add_u32 s40, s40, s63
  buffer_load_dwordx4 v5, s[48:51], s40 offen nt lds
  s_add_u32 m0, m0, s62
  s_add_u32 s40, s40, s63
  buffer_load_dwordx4 v5, s[48:51], s40 offen nt lds
  s_add_u32 m0, m0, s62
  s_add_u32 s40, s40, s63
  buffer_load_dwordx4 v4, s[48:51], s40 offen nt lds
  s_add_u32 m0, m0, s62
  s_add_u32 s40, s40, s63
  buffer_load_dwordx4 v4, s[48:51], s40 offen nt lds
  s_add_u32 m0, m0, s62
  s_add_u32 s40, s40, s63
  buffer_load_dwordx4 v5, s[48:51], s40 offen nt lds
  s_add_u32 m0, m0, s62
  s_add_u32 s40, s40, s63
  buffer_load_dwordx4 v5, s[48:51], s40 offen nt lds
  s_branch L_Yp0
L_w67:
  s_cmp_ge_u32 s38, 8
  s_cbranch_scc1 L_e1
  s_branch L_Yred
L_e1:
  s_cmp_ge_u32 s38, 16
  s_cbranch_scc1 L_eA
  s_sub_u32 s42, s39, 6
  s_sub_u32 s40, s38, 8
  s_add_u32 s41, s42, 12
  s_lshl_b32 s40, s40, s41
  s_lshl_b32 s41, s42, 15
  s_add_u32 s40, s40, s41
  s_mul_i32 s41, s37, 98304
  s_add_u32 s40, s40, s41
  s_add_u32 s40, s40, 524288
  s_lshl_b32 s42, 32, s42
  s_sub_u32 s42, s42, 1
  v_min_u32 v6, s42, v1
  v_lshlrev_b32 v6, 7, v6
  v_add_u32 v6, s40, v6
  s_waitcnt lgkmcnt(0)
  global_load_dword v31, v6, s[34:35] sc1
  s_branch L_roleX
L_eA:
  s_cmp_ge_u32 s38, 32
  s_cbranch_scc1 L_end
  s_lshl_b32 s41, s39, 1
  s_sub_u32 s41, 15, s41
  s_xor_b32 s41, s41, s37
  s_xor_b32 s41, s41, 7
  s_lshl_b32 s41, s41, 7
  s_mul_i32 s40, s38, 196608
  s_add_u32 s40, s40, s41
  s_lshl_b32 s41, s39, 10
  s_sub_u32 s40, s40, s41
  s_sub_u32 s40, s40, 3136512
  s_lshl_b32 s41, s39, 11
  s_sub_u32 s41, s41, 11264
  v_lshrrev_b32 v6, 1, v1
  v_mul_u32_u24 v6, 6144, v6
  v_and_b32 v7, 1, v1
  v_mad_u32_u24 v6, v7, s41, v6
  v_add_u32 v6, s40, v6
  s_waitcnt lgkmcnt(0)
  global_load_dword v31, v6, s[28:29]
L_eA2:
  s_waitcnt lgkmcnt(0)
  s_cmp_eq_u32 s39, 7
  s_cbranch_scc1 L_roleA
  s_cmp_eq_u32 s37, 7
  s_cselect_b32 s41, 16, 0
  s_lshl_b32 s40, s38, 18
  s_lshl_b32 s42, s37, 10
  s_add_u32 s40, s40, s42
  s_sub_u32 s40, s40, 4193920
  v_and_b32 v6, 31, v1
  v_lshlrev_b32 v6, 13, v6
  v_and_b32 v7, 32, v1
  v_mad_u32_u24 v6, v7, s41, v6
  v_add_u32 v6, s40, v6
  global_load_dword v31, v6, s[14:15]
  s_branch L_roleA
L_Yred:
  s_mov_b32 s56, 0x40000
  s_lshl_b32 s40, s38, 1
  s_add_u32 s40, s40, s39
  s_sub_u32 s4, s40, 18
  s_mul_i32 s40, s37, 98304
  s_lshl_b32 s41, s4, 13
  s_add_u32 s40, s40, s41
  s_add_u32 s5, s40, 524288
  s_add_u32 s6, s5, 786432
  v_lshlrev_b32 v136, 3, v1
  v_lshlrev_b32 v137, 7, v1
  v_mov_b32 v140, 0
  v_lshlrev_b32 v6, 10, v3
  v_lshl_add_u32 v7, v2, 4, v6
  s_xor_b32 s40, s37, 7
  s_lshl_b32 s40, s40, 7
  s_lshl_b32 s41, s4, 5
  s_add_u32 s40, s40, s41
  v_lshl_add_u32 v8, v2, 1, v6
  v_add_u32 v8, s40, v8
  s_waitcnt lgkmcnt(0)
  s_load_dword s36, s[34:35], 0
  s_mov_b32 s44, s34
  s_mov_b32 s45, s35
  s_mov_b32 s46, 0x400000
  s_mov_b32 s47, 0x20000
  s_cmp_lt_u32 s38, 6
  s_cbranch_scc1 L_Yr1
  global_load_dwordx4 v[100:103], v7, s[8:9]
  global_load_dwordx4 v[104:107], v7, s[8:9] offset:256
  global_load_dwordx4 v[108:111], v7, s[8:9] offset:512
  global_load_dwordx4 v[112:115], v7, s[8:9] offset:768
  global_load_short_d16_hi v140, v8, s[8:9]
  s_branch L_Yln
L_Yp0:
  s_setprio 3
  s_load_dword s36, s[34:35], 0
  s_mov_b32 s56, 0x40000
  s_mov_b32 s44, s34
  s_mov_b32 s45, s35
  s_mov_b32 s46, 0x400000
  s_mov_b32 s47, 0x20000
  s_mul_i32 s4, s37, 98304
  s_lshr_b32 s41, s39, 1
  s_lshl_b32 s41, s41, 15
  s_add_u32 s4, s4, s41
  s_and_b32 s41, s39, 1
  s_lshl_b32 s41, s41, 12
  s_add_u32 s4, s4, s41
  s_lshl_b32 s41, s38, 9
  s_add_u32 s4, s4, s41
  s_add_u32 s4, s4, 524288
  s_add_u32 s5, s4, 8192
  s_add_u32 s6, s4, 16384
  s_add_u32 s7, s4, 24576
  v_lshlrev_b32 v136, 3, v1
  s_mov_b32 s62, 0xbfb8aa3b
  s_lshl_b32 s43, s39, 13
  v_bfe_u32 v6, v1, 2, 2
  v_mul_u32_u24 v7, 16, v3
  v_add_u32 v7, v7, v6
  v_lshlrev_b32 v7, 7, v7
  v_and_b32 v8, 3, v1
  v_lshl_add_u32 v7, v8, 3, v7
  v_lshrrev_b32 v6, 1, v6
  v_and_b32 v8, 1, v3
  v_lshl_or_b32 v6, v8, 1, v6
  v_lshl_add_u32 v7, v6, 5, v7
  v_add_u32 v16, s43, v7
  v_xor_b32 v17, 32, v16
  v_xor_b32 v18, 64, v16
  v_xor_b32 v19, 0x60, v16
  s_waitcnt vmcnt(8)
  v_lshlrev_b32 v6, 16, v96
  v_and_b32 v7, 0xffff0000, v96
  v_lshlrev_b32 v8, 16, v97
  v_and_b32 v9, 0xffff0000, v97
  v_mul_f32 v10, s62, v6
  v_mul_f32 v11, s62, v7
  v_mul_f32 v12, s62, v8
  v_mul_f32 v13, s62, v9
  v_exp_f32 v10, v10
  v_exp_f32 v11, v11
  v_exp_f32 v12, v12
  v_exp_f32 v13, v13
  s_nop 0
  v_add_f32 v10, 1.0, v10
  v_add_f32 v11, 1.0, v11
  v_add_f32 v12, 1.0, v12
  v_add_f32 v13, 1.0, v13
  v_rcp_f32 v10, v10
  v_rcp_f32 v11, v11
  v_rcp_f32 v12, v12
  v_rcp_f32 v13, v13
  s_nop 0
  v_mul_f32 v6, v6, v10
  v_mul_f32 v7, v7, v11
  v_mul_f32 v8, v8, v12
  v_mul_f32 v9, v9, v13
  v_cvt_pk_bf16_f32 v20, v6, v7
  v_cvt_pk_bf16_f32 v21, v8, v9
  s_waitcnt lgkmcnt(0)
  s_add_u32 s36, s36, 0x9e3779b9
  v_mov_b32_dpp v22, v20 quad_perm:[1,1,3,3] row_mask:0xf bank_mask:0xf
  v_mov_b32_dpp v23, v21 quad_perm:[1,1,3,3] row_mask:0xf bank_mask:0xf
  v_mov_b32 v101, s36
  v_mov_b32 v103, s36
  v_mov_b32 v105, s36
  v_mov_b32 v107, s36
  s_waitcnt vmcnt(0)
  s_branch L_Yprod
L_Yrest:
  s_mov_b32 s56, 0x40000
  s_lshr_b32 s41, s39, 1
  s_lshl_b32 s42, s41, 1
  s_sub_u32 s42, 5, s42
  s_xor_b32 s42, s42, s37
  s_xor_b32 s42, s42, 7
  s_lshl_b32 s42, s42, 7
  s_add_u32 s40, s40, s42
  s_lshl_b32 s42, s39, 2
  s_lshr_b32 s42, 0x524310, s42
  s_and_b32 s42, s42, 7
  s_lshl_b32 s42, s42, 10
  s_add_u32 s40, s40, s42
  s_lshl_b32 s92, s2, 2
  s_lshr_b32 s93, s39, 1
  s_add_u32 s92, s92, s93
  s_lshr_b32 s93, s92, 6
  s_lshl_b32 s93, s93, 7
  s_and_b32 s92, s92, 63
  s_add_u32 s92, s92, s93
  s_and_b32 s93, s39, 1
  s_lshl_b32 s93, s93, 6
  s_add_u32 s92, s92, s93
  s_lshl_b32 s92, s92, 7
  s_add_u32 s92, s92, 3276800
  s_waitcnt lgkmcnt(0)
  s_memtime s[88:89]
  s_load_dword s95, s[34:35], s92
  s_mov_b32 s48, s28
  s_mov_b32 s49, s29
  global_load_dwordx2 v[96:97], v6, s[26:27]
  s_waitcnt lgkmcnt(0)
  s_memtime s[90:91]
  s_lshl_b32 s93, s39, 2
  s_add_u32 s93, s93, 134912
  v_mov_b32 v14, s93
  s_waitcnt lgkmcnt(0)
  s_load_dword s36, s[34:35], 0
  s_sub_u32 s90, s90, s88
  v_mov_b32 v15, s90
  ds_write_b32 v14, v15
  s_mov_b32 s44, s34
  s_mov_b32 s45, s35
  s_mov_b32 s46, 0x400000
  s_mov_b32 s47, 0x20000
  s_mul_i32 s4, s37, 98304
  s_lshr_b32 s41, s39, 1
  s_lshl_b32 s41, s41, 15
  s_add_u32 s4, s4, s41
  s_and_b32 s41, s39, 1
  s_lshl_b32 s41, s41, 12
  s_add_u32 s4, s4, s41
  s_lshl_b32 s41, s38, 9
  s_add_u32 s4, s4, s41
  s_add_u32 s4, s4, 524288
  s_add_u32 s5, s4, 8192
  s_add_u32 s6, s4, 16384
  s_add_u32 s7, s4, 24576
  v_lshlrev_b32 v136, 3, v1
  s_mov_b32 s62, 0xbfb8aa3b
  s_lshl_b32 s43, s39, 13
  v_bfe_u32 v6, v1, 2, 2
  v_mul_u32_u24 v7, 16, v3
  v_add_u32 v7, v7, v6
  v_lshlrev_b32 v7, 7, v7
  v_and_b32 v8, 3, v1
  v_lshl_add_u32 v7, v8, 3, v7
  v_lshrrev_b32 v6, 1, v6
  v_and_b32 v8, 1, v3
  v_lshl_or_b32 v6, v8, 1, v6
  v_lshl_add_u32 v7, v6, 5, v7
  v_add_u32 v16, s43, v7
  v_xor_b32 v17, 32, v16
  v_xor_b32 v18, 64, v16
  v_xor_b32 v19, 0x60, v16
  s_waitcnt vmcnt(0)
  v_lshlrev_b32 v6, 16, v96
  v_and_b32 v7, 0xffff0000, v96
  v_lshlrev_b32 v8, 16, v97
  v_and_b32 v9, 0xffff0000, v97
  v_mul_f32 v10, s62, v6
  v_mul_f32 v11, s62, v7
  v_mul_f32 v12, s62, v8
  v_mul_f32 v13, s62, v9
  v_exp_f32 v10, v10
  v_exp_f32 v11, v11
  v_exp_f32 v12, v12
  v_exp_f32 v13, v13
  s_nop 0
  v_add_f32 v10, 1.0, v10
  v_add_f32 v11, 1.0, v11
  v_add_f32 v12, 1.0, v12
  v_add_f32 v13, 1.0, v13
  v_rcp_f32 v10, v10
  v_rcp_f32 v11, v11
  v_rcp_f32 v12, v12
  v_rcp_f32 v13, v13
  s_nop 0
  v_mul_f32 v6, v6, v10
  v_mul_f32 v7, v7, v11
  v_mul_f32 v8, v8, v12
  v_mul_f32 v9, v9, v13
  v_cvt_pk_bf16_f32 v20, v6, v7
  v_cvt_pk_bf16_f32 v21, v8, v9
  s_waitcnt lgkmcnt(0)
  s_add_u32 s36, s36, 0x9e3779b9
  v_mov_b32_dpp v22, v20 quad_perm:[1,1,3,3] row_mask:0xf bank_mask:0xf
  v_mov_b32_dpp v23, v21 quad_perm:[1,1,3,3] row_mask:0xf bank_mask:0xf
  v_mov_b32 v101, s36
  v_mov_b32 v103, s36
  v_mov_b32 v105, s36
  v_mov_b32 v107, s36
  s_barrier
  s_barrier
  s_nop 0
  buffer_load_dwordx4 v4, s[48:51], s40 offen nt lds
  s_add_u32 m0, m0, 1024
  s_add_u32 s40, s40, 49152
  buffer_load_dwordx4 v4, s[48:51], s40 offen nt lds
  s_add_u32 m0, m0, 1024
  s_add_u32 s40, s40, 49152
  buffer_load_dwordx4 v5, s[48:51], s40 offen nt lds
  s_add_u32 m0, m0, 1024
  s_add_u32 s40, s40, 49152
  buffer_load_dwordx4 v5, s[48:51], s40 offen nt lds
  s_add_u32 m0, m0, 1024
  s_add_u32 s40, s40, 49152
  buffer_load_dwordx4 v4, s[48:51], s40 offen nt lds
  s_add_u32 m0, m0, 1024
  s_add_u32 s40, s40, 49152
  buffer_load_dwordx4 v4, s[48:51], s40 offen nt lds
  s_add_u32 m0, m0, 1024
  s_add_u32 s40, s40, 49152
  buffer_load_dwordx4 v5, s[48:51], s40 offen nt lds
  s_add_u32 m0, m0, 1024
  s_add_u32 s40, s40, 49152
  buffer_load_dwordx4 v5, s[48:51], s40 offen nt lds
  s_waitcnt vmcnt(0)
L_Yprod:
  ds_read_b64_tr_b16 v[32:33], v16 offset:0
  ds_read_b64_tr_b16 v[34:35], v16 offset:512
  ds_read_b64_tr_b16 v[40:41], v17 offset:0
  ds_read_b64_tr_b16 v[42:43], v17 offset:512
  ds_read_b64_tr_b16 v[48:49], v18 offset:0
  ds_read_b64_tr_b16 v[50:51], v18 offset:512
  ds_read_b64_tr_b16 v[56:57], v19 offset:0
  ds_read_b64_tr_b16 v[58:59], v19 offset:512
  ds_read_b64_tr_b16 v[36:37], v16 offset:1024
  ds_read_b64_tr_b16 v[38:39], v16 offset:1536
  ds_read_b64_tr_b16 v[44:45], v17 offset:1024
  ds_read_b64_tr_b16 v[46:47], v17 offset:1536
  ds_read_b64_tr_b16 v[52:53], v18 offset:1024
  ds_read_b64_tr_b16 v[54:55], v18 offset:1536
  ds_read_b64_tr_b16 v[60:61], v19 offset:1024
  ds_read_b64_tr_b16 v[62:63], v19 offset:1536
  s_waitcnt lgkmcnt(0)
  v_mfma_f32_16x16x32_bf16 v[64:67], v[20:23], v[32:35], 0
  v_mfma_f32_16x16x32_bf16 v[68:71], v[20:23], v[36:39], 0
  v_mfma_f32_16x16x32_bf16 v[72:75], v[20:23], v[40:43], 0
  v_mfma_f32_16x16x32_bf16 v[76:79], v[20:23], v[44:47], 0
  v_mfma_f32_16x16x32_bf16 v[80:83], v[20:23], v[48:51], 0
  v_mfma_f32_16x16x32_bf16 v[84:87], v[20:23], v[52:55], 0
  v_mfma_f32_16x16x32_bf16 v[88:91], v[20:23], v[56:59], 0
  v_mfma_f32_16x16x32_bf16 v[92:95], v[20:23], v[60:63], 0
  s_nop 1
  v_add_f32 v100, v64, v70
  s_nop 0
  v_add_f32 v102, v72, v78
  s_nop 0
  v_add_f32 v104, v80, v86
  s_nop 0
  v_add_f32 v106, v88, v94
  buffer_store_dwordx2 v[100:101], v136, s[44:47], s4 offen
  buffer_store_dwordx2 v[102:103], v136, s[44:47], s5 offen
  buffer_store_dwordx2 v[104:105], v136, s[44:47], s6 offen
  buffer_store_dwordx2 v[106:107], v136, s[44:47], s7 offen
  s_lshl_b32 s40, s39, 10
  s_add_u32 s40, s40, 98304
  v_lshlrev_b32 v6, 2, v1
  v_add_u32 v6, s40, v6
  ds_write2st64_b32 v6, v100, v102 offset0:0 offset1:1
  ds_write2st64_b32 v6, v104, v106 offset0:2 offset1:3
  s_setprio 0
  s_waitcnt lgkmcnt(0)
  s_barrier
  s_cmp_ge_u32 s39, 2
  s_cbranch_scc1 L_Yb2
  s_branch L_Yb23
L_repub:
  v_lshlrev_b32 v216, 2, v1
  v_add_u32 v216, 98304, v216
  v_lshlrev_b32 v217, 3, v1
  v_mov_b32 v219, s36
  s_mul_i32 s10, s37, 98304
  s_lshl_b32 s11, s38, 9
  s_add_u32 s10, s10, s11
  s_add_u32 s10, s10, 1310720
  s_mov_b32 s11, 0
L_repub1:
  ds_read_b32 v218, v216
  s_lshr_b32 s32, s11, 3
  s_lshl_b32 s32, s32, 15
  s_and_b32 s33, s11, 3
  s_lshl_b32 s33, s33, 13
  s_add_u32 s32, s32, s33
  s_and_b32 s33, s11, 4
  s_lshl_b32 s33, s33, 10
  s_add_u32 s32, s32, s33
  s_add_u32 s32, s32, s10
  v_add_u32 v216, 256, v216
  s_waitcnt lgkmcnt(0)
  buffer_store_dwordx2 v[218:219], v217, s[44:47], s32 offen sc1
  s_add_u32 s11, s11, 1
  s_cmp_lt_u32 s11, s18
  s_cbranch_scc1 L_repub1
  s_setpc_b64 s[100:101]
L_Yln:
  s_setprio 3
  s_waitcnt vmcnt(0)
  v_mov_b32 v10, 0x3f803f80
  v_dot2_f32_bf16 v6, v100, v10, 0
  v_dot2_f32_bf16 v8, v100, v100, 0
  v_dot2_f32_bf16 v7, v101, v10, 0
  v_dot2_f32_bf16 v9, v101, v101, 0
  v_dot2_f32_bf16 v6, v102, v10, v6
  v_dot2_f32_bf16 v8, v102, v102, v8
  v_dot2_f32_bf16 v7, v103, v10, v7
  v_dot2_f32_bf16 v9, v103, v103, v9
  v_dot2_f32_bf16 v6, v104, v10, v6
  v_dot2_f32_bf16 v8, v104, v104, v8
  v_dot2_f32_bf16 v7, v105, v10, v7
  v_dot2_f32_bf16 v9, v105, v105, v9
  v_dot2_f32_bf16 v6, v106, v10, v6
  v_dot2_f32_bf16 v8, v106, v106, v8
  v_dot2_f32_bf16 v7, v107, v10, v7
  v_dot2_f32_bf16 v9, v107, v107, v9
  v_dot2_f32_bf16 v6, v108, v10, v6
  v_dot2_f32_bf16 v8, v108, v108, v8
  v_dot2_f32_bf16 v7, v109, v10, v7
  v_dot2_f32_bf16 v9, v109, v109, v9
  v_dot2_f32_bf16 v6, v110, v10, v6
  v_dot2_f32_bf16 v8, v110, v110, v8
  v_dot2_f32_bf16 v7, v111, v10, v7
  v_dot2_f32_bf16 v9, v111, v111, v9
  v_dot2_f32_bf16 v6, v112, v10, v6
  v_dot2_f32_bf16 v8, v112, v112, v8
  v_dot2_f32_bf16 v7, v113, v10, v7
  v_dot2_f32_bf16 v9, v113, v113, v9
  v_dot2_f32_bf16 v6, v114, v10, v6
  v_dot2_f32_bf16 v8, v114, v114, v8
  v_dot2_f32_bf16 v7, v115, v10, v7
  v_dot2_f32_bf16 v9, v115, v115, v9
  s_nop 2
  v_add_f32 v6, v6, v7
  v_add_f32 v8, v8, v9
  s_nop 0
  v_add_f32_dpp v6, v6, v6 quad_perm:[1,0,3,2] row_mask:0xf bank_mask:0xf
  v_add_f32_dpp v8, v8, v8 quad_perm:[1,0,3,2] row_mask:0xf bank_mask:0xf
  s_nop 0
  v_add_f32_dpp v6, v6, v6 quad_perm:[2,3,0,1] row_mask:0xf bank_mask:0xf
  v_add_f32_dpp v8, v8, v8 quad_perm:[2,3,0,1] row_mask:0xf bank_mask:0xf
  s_nop 0
  v_add_f32_dpp v6, v6, v6 row_half_mirror row_mask:0xf bank_mask:0xf
  v_add_f32_dpp v8, v8, v8 row_half_mirror row_mask:0xf bank_mask:0xf
  s_nop 0
  v_add_f32_dpp v6, v6, v6 row_mirror row_mask:0xf bank_mask:0xf
  v_add_f32_dpp v8, v8, v8 row_mirror row_mask:0xf bank_mask:0xf
  v_mul_f32 v6, 0x3b000000, v6
  v_mul_f32 v8, 0x3b000000, v8
  v_fma_f32 v8, -v6, v6, v8
  v_max_f32 v8, 0, v8
  v_cvt_pk_bf16_f32 v6, v6, v6
  v_and_b32 v6, 0xffff0000, v6
  v_cvt_pk_bf16_f32 v8, v8, v8
  v_and_b32 v8, 0xffff0000, v8
  v_add_f32 v8, 0x3727c5ac, v8
  v_cvt_pk_bf16_f32 v8, v8, v8
  v_and_b32 v8, 0xffff0000, v8
  v_sqrt_f32 v8, v8
  v_sub_f32 v140, v140, v6
  v_cvt_pk_bf16_f32 v8, v8, v8
  v_and_b32 v8, 0xffff0000, v8
  v_rcp_f32 v8, v8
  v_cvt_pk_bf16_f32 v140, v140, v140
  v_and_b32 v140, 0xffff0000, v140
  v_mul_f32 v140, v140, v8
  v_cvt_pk_bf16_f32 v140, v140, v140
  v_and_b32 v140, 0xffff0000, v140
  s_waitcnt lgkmcnt(0)
  s_add_u32 s36, s36, 0x9e3779b9
  v_mov_b32 v30, s36
  s_mov_b32 s18, 8
  s_barrier
  s_branch L_Yjob
L_Yr1:
  s_waitcnt lgkmcnt(0)
  s_add_u32 s36, s36, 0x9e3779b9
  s_barrier
L_Yb23:
  s_barrier
  s_barrier
  s_cmp_lt_u32 s38, 6
  s_cbranch_scc1 L_Yb2
  v_mov_b32 v30, s36
  s_mov_b32 s18, 24
  s_and_b32 s40, s39, 3
  s_lshl_b32 s40, s40, 1
  s_add_u32 s4, s38, s40
  s_sub_u32 s4, s4, 2
  s_mul_i32 s40, s37, 98304
  s_lshl_b32 s41, s4, 13
  s_add_u32 s40, s40, s41
  s_add_u32 s5, s40, 524288
  s_add_u32 s6, s5, 786432
L_Yjob0:
L_Yjob:
  s_sub_u32 s56, s56, 1
  s_cbranch_scc1 L_abort
  s_and_b32 s100, s56, 255
  s_cbranch_scc1 L_1
  s_call_b64 s[100:101], L_repub
L_1:
  s_bitcmp1_b32 s56, 9
  s_cselect_b32 s40, s5, s6
  s_add_u32 s41, s40, 4096
  buffer_load_dwordx2 v[100:101], v136, s[44:47], s40 offen offset:0 sc1
  buffer_load_dwordx2 v[102:103], v136, s[44:47], s40 offen offset:512 sc1
  buffer_load_dwordx2 v[104:105], v136, s[44:47], s40 offen offset:1024 sc1
  buffer_load_dwordx2 v[106:107], v136, s[44:47], s40 offen offset:1536 sc1
  buffer_load_dwordx2 v[108:109], v136, s[44:47], s40 offen offset:2048 sc1
  buffer_load_dwordx2 v[110:111], v136, s[44:47], s40 offen offset:2560 sc1
  buffer_load_dwordx2 v[112:113], v136, s[44:47], s40 offen offset:3072 sc1
  buffer_load_dwordx2 v[114:115], v136, s[44:47], s40 offen offset:3584 sc1
  buffer_load_dwordx2 v[116:117], v136, s[44:47], s41 offen offset:0 sc1
  buffer_load_dwordx2 v[118:119], v136, s[44:47], s41 offen offset:512 sc1
  buffer_load_dwordx2 v[120:121], v136, s[44:47], s41 offen offset:1024 sc1
  buffer_load_dwordx2 v[122:123], v136, s[44:47], s41 offen offset:1536 sc1
  buffer_load_dwordx2 v[124:125], v136, s[44:47], s41 offen offset:2048 sc1
  buffer_load_dwordx2 v[126:127], v136, s[44:47], s41 offen offset:2560 sc1
  buffer_load_dwordx2 v[128:129], v136, s[44:47], s41 offen offset:3072 sc1
  buffer_load_dwordx2 v[130:131], v136, s[44:47], s41 offen offset:3584 sc1
  v_mov_b32 v6, 134920
  ds_read_b64 v[8:9], v6 offset:0
  ds_read_b64 v[10:11], v6 offset:8
  s_waitcnt lgkmcnt(0)
  v_min_u32 v8, v8, v10
  v_min_u32 v9, v9, v11
  v_cmp_lt_u32 vcc, v9, v8
  s_cmp_lg_u64 vcc, 0
  s_cselect_b32 s7, 8192, 0
  s_lshr_b32 s7, s7, 13
  s_getreg_b32 s40, hwreg(HW_REG_XCC_ID, 2, 1)
  s_xor_b32 s7, s7, s40
  s_xor_b32 s7, s7, s36
  s_waitcnt vmcnt(0)
  v_bitop3_b32 v6, v101, v103, v30 bitop3:0x7e
  v_bitop3_b32 v7, v105, v107, v30 bitop3:0x7e
  v_bitop3_b32 v8, v109, v111, v30 bitop3:0x7e
  v_bitop3_b32 v9, v113, v115, v30 bitop3:0x7e
  v_bitop3_b32 v10, v117, v119, v30 bitop3:0x7e
  v_bitop3_b32 v11, v121, v123, v30 bitop3:0x7e
  v_bitop3_b32 v12, v125, v127, v30 bitop3:0x7e
  v_bitop3_b32 v13, v129, v131, v30 bitop3:0x7e
  v_or3_b32 v6, v6, v7, v8
  v_or3_b32 v9, v9, v10, v11
  v_or3_b32 v6, v6, v12, v13
  v_or_b32 v6, v6, v9
  v_cmp_ne_u32 vcc, 0, v6
  s_cbranch_vccnz L_Yjob0
  v_add_f32 v100, v100, v108
  v_add_f32 v102, v102, v110
  v_add_f32 v104, v104, v112
  v_add_f32 v106, v106, v114
  v_add_f32 v116, v116, v124
  v_add_f32 v118, v118, v126
  v_add_f32 v120, v120, v128
  v_add_f32 v122, v122, v130
  v_add_f32 v100, v100, v104
  v_add_f32 v102, v102, v106
  v_add_f32 v116, v116, v120
  v_add_f32 v118, v118, v122
  v_add_f32 v100, v100, v102
  v_add_f32 v116, v116, v118
  v_cvt_pk_bf16_f32 v6, v100, v116
  s_cmp_ge_u32 s4, 4
  s_cbranch_scc1 L_2
  v_and_b32 v8, 0xffff0000, v6
  v_add_f32 v8, 1.0, v8
  v_cvt_pk_bf16_f32 v8, v8, v8
  v_and_b32 v8, 0xffff0000, v8
  v_mul_f32 v8, v8, v140
  v_cvt_pk_bf16_f32 v8, v8, v8
  v_and_b32 v8, 0xffff0000, v8
  v_lshlrev_b32 v6, 16, v6
  v_add_f32 v8, v8, v6
  v_mov_b32 v7, s7
  s_xor_b32 s40, s37, 7
  s_lshl_b32 s40, s40, 10
  v_mov_b32_dpp v9, v8 quad_perm:[1,1,3,3] row_mask:0xf bank_mask:0xf
  s_lshl_b32 s41, s4, 8
  s_add_u32 s40, s40, s41
  s_add_u32 s40, s40, 3211264
  v_cvt_pk_bf16_f32 v6, v8, v9
  v_lshlrev_b32 v8, 2, v1
  s_mov_b32 exec_lo, 0x55555555
  s_mov_b32 exec_hi, 0x55555555
  buffer_store_dwordx2 v[6:7], v8, s[44:47], s40 offen sc1
  s_add_u32 s40, s40, 8192
  buffer_store_dwordx2 v[6:7], v8, s[44:47], s40 offen sc1
  s_mov_b64 exec, -1
  s_branch L_Yb23
L_2:
  v_mov_b32 v7, s7
  s_lshr_b32 s40, s4, 2
  s_lshl_b32 s41, s40, 1
  s_sub_u32 s41, 5, s41
  s_xor_b32 s41, s41, s37
  s_xor_b32 s41, s41, 7
  s_lshl_b32 s41, s41, 6
  s_and_b32 s42, s4, 3
  s_lshl_b32 s42, s42, 4
  s_add_u32 s41, s41, s42
  v_add_u32 v9, s41, v2
  v_lshlrev_b32 v8, 3, v9
  s_mov_b32 s40, 49152
  s_cmp_ge_u32 s4, 8
  s_cbranch_scc1 L_3
  v_and_b32 v8, 0xffff0000, v6
  v_add_f32 v8, 1.0, v8
  v_cvt_pk_bf16_f32 v6, v100, v8
  v_and_b32 v8, 0x101, v9
  v_lshlrev_b32 v8, 3, v8
  v_bfe_u32 v10, v9, 1, 1
  v_lshl_add_u32 v8, v10, 10, v8
  v_bfe_u32 v10, v9, 7, 1
  v_lshl_add_u32 v8, v10, 9, v8
  v_bfe_u32 v10, v9, 2, 1
  v_lshl_add_u32 v8, v10, 8, v8
  v_bfe_u32 v10, v9, 3, 4
  v_lshl_add_u32 v8, v10, 4, v8
  s_mov_b32 s40, 32768
L_3:
  v_lshl_add_u32 v8, v3, 12, v8
  buffer_store_dwordx2 v[6:7], v8, s[44:47], s40 offen sc1
L_Yjd:
L_Yb2:
  s_setprio 0
  s_mov_b32 s18, 24
  v_mov_b32 v30, s36
  s_and_b32 s57, s37, 3
  s_lshl_b32 s57, s57, 1
  s_lshr_b32 s40, s37, 2
  s_xor_b32 s40, s40, 1
  s_add_u32 s57, s57, s40
  s_and_b32 s40, s57, 1
  s_lshl_b32 s40, s40, 3
  s_add_u32 s40, s40, s38
  s_cmp_ge_u32 s40, 14
  s_cbranch_scc1 L_Yspare
  s_lshr_b32 s57, s57, 1
  s_mul_i32 s57, s57, 14
  s_add_u32 s57, s57, s40
  s_and_b32 s4, s57, 0
  s_lshl_b32 s40, s4, 2
  s_xor_b32 s5, s39, s40
  v_and_b32 v6, 7, v1
  v_bfe_u32 v7, v1, 4, 1
  v_lshlrev_b32 v7, 1, v7
  v_xor_b32 v6, v6, v7
  v_and_b32 v7, 3, v6
  v_lshrrev_b32 v8, 3, v1
  v_mul_u32_u24 v8, 3584, v8
  v_lshl_add_u32 v8, v7, 4, v8
  s_mul_i32 s41, s5, 229376
  s_lshl_b32 s42, s57, 6
  s_add_u32 s41, s41, s42
  s_mul_i32 s42, s4, 114688
  s_add_u32 s43, s41, s42
  s_sub_u32 s41, s41, s42
  s_add_u32 s41, s41, 114688
  v_xor_b32 v14, s40, v6
  v_cmp_gt_u32 vcc, 4, v14
  v_mov_b32 v10, s20
  v_mov_b32 v11, s21
  v_mov_b32 v12, s22
  v_mov_b32 v13, s23
  v_cndmask_b32 v96, v12, v10, vcc
  v_cndmask_b32 v97, v13, v11, vcc
  v_cndmask_b32 v98, v10, v12, vcc
  v_cndmask_b32 v99, v11, v13, vcc
  v_mov_b32 v11, 0
  v_add_u32 v10, s43, v8
  v_lshl_add_u64 v[96:97], v[10:11], 0, v[96:97]
  v_add_u32 v10, s41, v8
  v_lshl_add_u64 v[98:99], v[10:11], 0, v[98:99]
  s_mov_b32 s58, 28672
  s_mov_b32 s59, 0
  s_lshl_b32 s5, s5, 13
  s_lshl_b32 s40, s4, 12
  s_add_u32 s6, s5, s40
  s_xor_b32 s7, s6, 4096
  v_lshrrev_b32 v7, 3, v1
  v_lshlrev_b32 v4, 10, v7
  v_lshl_add_u32 v4, v6, 4, v4
  v_xor_b32 v5, 64, v4
  s_lshl_b32 s40, s57, 15
  s_lshl_b32 s41, s39, 7
  s_add_u32 s40, s40, s41
  s_lshl_b32 s43, s39, 12
  s_add_u32 m0, s43, 65536
  s_mov_b32 s48, s24
  s_mov_b32 s49, s25
  s_mov_b32 s50, 0x1c0000
  s_mov_b32 s51, 0x20000
  s_barrier
  s_cmp_ge_u32 s38, 6
  s_cbranch_scc1 L_4
  s_mul_i32 s10, s39, 6
  s_add_u32 s10, s10, s38
  v_lshlrev_b32 v14, 7, v1
  s_and_b32 s32, s57, 6
  s_cmp_eq_u32 s32, 6
  s_cselect_b32 s32, 48, 48
  s_cmp_ge_u32 s10, s32
  s_cbranch_scc1 L_5
  s_lshl_b32 s32, s37, 19
  s_and_b32 s33, s10, 7
  s_lshl_b32 s33, s33, 16
  s_add_u32 s32, s32, s33
  s_lshr_b32 s33, s10, 3
  s_lshl_b32 s33, s33, 13
  s_sub_u32 s32, s32, s33
  s_add_u32 s32, s32, 57344
  v_add_u32 v15, s32, v14
  global_load_dword v31, v15, s[16:17]
L_5:
  s_barrier
L_4:
  s_mov_b32 s4, s40
  v_lshrrev_b32 v6, 1, v3
  v_lshlrev_b32 v6, 7, v6
  v_lshl_add_u32 v6, v2, 3, v6
  v_and_b32 v7, 1, v3
  v_lshl_add_u32 v188, v7, 2, v6
  s_and_b32 s40, s39, 3
  s_lshl_b32 s40, s40, 10
  v_lshlrev_b32 v189, 1, v188
  v_add_u32 v189, s40, v189
  s_lshl_b32 s40, s40, 2
  v_lshlrev_b32 v190, 4, v1
  v_add_u32 v190, s40, v190
  v_lshrrev_b32 v6, 1, v3
  v_lshlrev_b32 v191, 14, v6
  v_lshl_add_u32 v191, v7, 12, v191
  v_lshl_add_u32 v191, v2, 4, v191
  v_lshrrev_b32 v6, 6, v188
  v_lshlrev_b32 v192, 17, v6
  v_bfe_u32 v6, v188, 3, 1
  v_lshl_add_u32 v192, v6, 14, v192
  v_bfe_u32 v6, v188, 4, 2
  v_lshl_add_u32 v192, v6, 5, v192
  v_lshl_add_u32 v192, v7, 4, v192
  v_and_b32 v193, 7, v2
  v_lshlrev_b32 v193, 7, v193
  s_mov_b32 s62, 32768
  s_mov_b32 s63, 4096
  s_cmp_ge_u32 s39, 4
  s_cbranch_scc1 L_7
  global_load_dwordx2 v[148:149], v189, s[8:9]
  global_load_dwordx2 v[150:151], v189, s[8:9] offset:512
L_7:
  s_waitcnt vmcnt(0)
  s_barrier
  s_lshl_b32 s43, s39, 12
  s_add_u32 m0, s43, 65536
  s_nop 0
  buffer_load_dwordx4 v4, s[48:51], s4 offen nt lds
  s_add_u32 m0, m0, 1024
  s_add_u32 s4, s4, 8192
  buffer_load_dwordx4 v5, s[48:51], s4 offen nt lds
  s_add_u32 m0, m0, 1024
  s_add_u32 s4, s4, 8192
  buffer_load_dwordx4 v4, s[48:51], s4 offen nt lds
  s_add_u32 m0, m0, 1024
  s_add_u32 s4, s4, 8192
  buffer_load_dwordx4 v5, s[48:51], s4 offen nt lds
  s_add_u32 m0, s6, 0
  s_waitcnt vmcnt(3)
  global_load_lds_dwordx4 v[96:97], off
  v_lshl_add_u64 v[96:97], v[96:97], 0, s[58:59]
  s_add_u32 m0, s6, 1024
  s_waitcnt vmcnt(3)
  global_load_lds_dwordx4 v[96:97], off
  v_lshl_add_u64 v[96:97], v[96:97], 0, s[58:59]
  s_add_u32 m0, s7, 0
  s_waitcnt vmcnt(3)
  global_load_lds_dwordx4 v[98:99], off
  v_lshl_add_u64 v[98:99], v[98:99], 0, s[58:59]
  s_add_u32 m0, s7, 1024
  s_waitcnt vmcnt(3)
  global_load_lds_dwordx4 v[98:99], off
  v_lshl_add_u64 v[98:99], v[98:99], 0, s[58:59]
  s_cmp_gt_u32 s39, 4
  s_cbranch_scc1 L_8
  s_cmp_lt_u32 s39, 4
  s_cbranch_scc1 L_9
  buffer_load_dword v116, v193, s[44:47], s63 offen sc1
  s_branch L_8
L_9:
  buffer_load_dwordx4 v[116:119], v190, s[44:47], s62 offen offset:0 sc1
  buffer_load_dwordx4 v[120:123], v190, s[44:47], s62 offen offset:1024 sc1
  buffer_load_dwordx4 v[124:127], v190, s[44:47], s62 offen offset:2048 sc1
  buffer_load_dwordx4 v[128:131], v190, s[44:47], s62 offen offset:3072 sc1
L_8:
  s_add_u32 m0, s6, 2048
  s_waitcnt vmcnt(5)
  global_load_lds_dwordx4 v[96:97], off
  v_lshl_add_u64 v[96:97], v[96:97], 0, s[58:59]
  s_add_u32 m0, s6, 3072
  s_waitcnt vmcnt(5)
  global_load_lds_dwordx4 v[96:97], off
  v_lshl_add_u64 v[96:97], v[96:97], 0, s[58:59]
  s_add_u32 m0, s7, 2048
  s_waitcnt vmcnt(5)
  global_load_lds_dwordx4 v[98:99], off
  v_lshl_add_u64 v[98:99], v[98:99], 0, s[58:59]
  s_add_u32 m0, s7, 3072
  s_waitcnt vmcnt(5)
  global_load_lds_dwordx4 v[98:99], off
  v_lshl_add_u64 v[98:99], v[98:99], 0, s[58:59]
  s_cmp_gt_u32 s39, 4
  s_cbranch_scc1 L_6
  s_waitcnt vmcnt(4)
  s_cmp_lt_u32 s39, 4
  s_cbranch_scc1 L_11
  s_branch L_Gcd2
L_Gcd:
  s_sub_u32 s56, s56, 1
  s_cbranch_scc1 L_abort
  s_and_b32 s100, s56, 255
  s_cbranch_scc1 L_12
  s_call_b64 s[100:101], L_repub
L_12:
  buffer_load_dword v116, v193, s[44:47], s63 offen sc1
  s_waitcnt vmcnt(0)
L_Gcd2:
  v_cmp_ne_u32 vcc, s36, v116
  s_cbranch_vccnz L_Gcd
  s_branch L_6
L_10:
  s_sub_u32 s56, s56, 1
  s_cbranch_scc1 L_abort
  s_and_b32 s100, s56, 255
  s_cbranch_scc1 L_13
  s_call_b64 s[100:101], L_repub
L_13:
  buffer_load_dwordx4 v[116:119], v190, s[44:47], s62 offen offset:0 sc1
  buffer_load_dwordx4 v[120:123], v190, s[44:47], s62 offen offset:1024 sc1
  buffer_load_dwordx4 v[124:127], v190, s[44:47], s62 offen offset:2048 sc1
  buffer_load_dwordx4 v[128:131], v190, s[44:47], s62 offen offset:3072 sc1
  s_waitcnt vmcnt(0)
L_11:
  v_bitop3_b32 v6, v117, v119, v30 bitop3:0x7e
  v_bitop3_b32 v7, v121, v123, v30 bitop3:0x7e
  v_bitop3_b32 v8, v125, v127, v30 bitop3:0x7e
  v_bitop3_b32 v9, v129, v131, v30 bitop3:0x7e
  v_or3_b32 v10, v6, v7, v8
  v_or_b32 v10, v10, v9
  v_cmp_lt_u32 vcc, 1, v10
  s_cbranch_vccnz L_10
  v_cmp_eq_u32 vcc, 1, v6
  s_bcnt1_i32_b64 s40, vcc
  v_cmp_eq_u32 vcc, 1, v8
  s_bcnt1_i32_b64 s41, vcc
  s_add_u32 s40, s40, s41
  s_getreg_b32 s41, hwreg(HW_REG_XCC_ID, 2, 1)
  s_cmp_gt_u32 s40, 64
  s_cselect_b32 s63, 1, 0
  s_xor_b32 s63, s63, s41
  s_lshl_b32 s63, s63, 13
  v_lshlrev_b32 v156, 16, v148
  v_and_b32 v157, 0xffff0000, v148
  v_lshlrev_b32 v158, 16, v149
  v_and_b32 v159, 0xffff0000, v149
  v_lshlrev_b32 v160, 16, v150
  v_and_b32 v161, 0xffff0000, v150
  v_lshlrev_b32 v162, 16, v151
  v_and_b32 v163, 0xffff0000, v151
  v_lshlrev_b32 v172, 16, v116
  v_and_b32 v180, 0xffff0000, v116
  v_lshlrev_b32 v173, 16, v118
  v_and_b32 v181, 0xffff0000, v118
  v_lshlrev_b32 v174, 16, v120
  v_and_b32 v182, 0xffff0000, v120
  v_lshlrev_b32 v175, 16, v122
  v_and_b32 v183, 0xffff0000, v122
  v_lshlrev_b32 v176, 16, v124
  v_and_b32 v184, 0xffff0000, v124
  v_lshlrev_b32 v177, 16, v126
  v_and_b32 v185, 0xffff0000, v126
  v_lshlrev_b32 v178, 16, v128
  v_and_b32 v186, 0xffff0000, v128
  v_lshlrev_b32 v179, 16, v130
  v_and_b32 v187, 0xffff0000, v130
  v_and_b32 v6, 1, v2
  v_lshlrev_b32 v6, 4, v6
  v_mov_b32 v7, 0x3f80
  v_lshlrev_b32 v7, v6, v7
  v_lshrrev_b32 v6, 1, v2
  v_cmp_eq_u32 vcc, 0, v6
  s_nop 1
  v_cndmask_b32 v148, 0, v7, vcc
  v_cmp_eq_u32 vcc, 1, v6
  s_nop 1
  v_cndmask_b32 v149, 0, v7, vcc
  v_cmp_eq_u32 vcc, 2, v6
  s_nop 1
  v_cndmask_b32 v150, 0, v7, vcc
  v_cmp_eq_u32 vcc, 3, v6
  s_nop 1
  v_cndmask_b32 v151, 0, v7, vcc
  v_cmp_eq_u32 vcc, 4, v6
  s_nop 1
  v_cndmask_b32 v152, 0, v7, vcc
  v_cmp_eq_u32 vcc, 5, v6
  s_nop 1
  v_cndmask_b32 v153, 0, v7, vcc
  v_cmp_eq_u32 vcc, 6, v6
  s_nop 1
  v_cndmask_b32 v154, 0, v7, vcc
  v_cmp_eq_u32 vcc, 7, v6
  s_nop 1
  v_cndmask_b32 v155, 0, v7, vcc
L_6:
  v_add_u32 v189, 143360, v189
  v_lshrrev_b32 v6, 2, v2
  v_mul_u32_u24 v193, 1024, v6
  v_lshl_add_u32 v193, v3, 6, v193
  v_and_b32 v7, 3, v2
  v_lshl_add_u32 v193, v7, 4, v193
  s_lshr_b32 s40, s39, 1
  s_lshl_b32 s41, s40, 8
  s_add_u32 s41, s41, 143360
  v_add_u32 v193, s41, v193
  s_mul_i32 s40, s40, 1280
  s_and_b32 s41, s39, 1
  s_lshl_b32 s41, s41, 6
  s_add_u32 s40, s40, s41
  s_add_u32 s40, s40, 135168
  v_mul_u32_u24 v194, 320, v3
  v_lshl_add_u32 v194, v2, 2, v194
  v_add_u32 v194, s40, v194
  v_mul_u32_u24 v195, 320, v6
  v_lshl_add_u32 v195, v3, 5, v195
  v_lshl_add_u32 v195, v7, 3, v195
  v_add_u32 v195, 135168, v195
  v_lshrrev_b32 v8, 3, v1
  v_lshlrev_b32 v4, 14, v8
  v_and_b32 v8, 7, v1
  v_lshl_add_u32 v4, v8, 4, v4
  s_and_b32 s6, s39, 7
  s_lshl_b32 s6, s6, 17
  s_lshl_b32 s41, s57, 7
  s_add_u32 s6, s6, s41
  s_add_u32 s6, s6, 2097152
  s_add_u32 s7, s6, 8192
  s_mov_b32 s62, 0xbfb8aa3b
  s_lshl_b32 s28, s57, 7
  s_add_u32 s28, s28, 3227648
  v_lshrrev_b32 v200, 5, v1
  v_lshlrev_b32 v200, 13, v200
  v_and_b32 v201, 31, v1
  v_lshl_add_u32 v200, v201, 2, v200
  s_lshr_b32 s43, s39, 1
  s_lshl_b32 s43, s43, 14
  v_bfe_u32 v6, v1, 2, 2
  v_mul_u32_u24 v7, 32, v3
  v_add_u32 v7, v7, v6
  v_lshlrev_b32 v7, 7, v7
  v_and_b32 v8, 3, v1
  v_lshl_add_u32 v7, v8, 3, v7
  v_lshrrev_b32 v6, 1, v6
  v_and_b32 v8, 1, v3
  v_lshl_or_b32 v6, v8, 1, v6
  v_lshl_add_u32 v7, v6, 5, v7
  v_add_u32 v16, s43, v7
  v_xor_b32 v17, 32, v16
  v_xor_b32 v18, 64, v16
  v_xor_b32 v19, 0x60, v16
  s_and_b32 s40, s39, 1
  s_lshl_b32 s40, s40, 5
  v_xor_b32 v96, s40, v16
  v_xor_b32 v97, 64, v96
  s_and_b32 s43, s39, 7
  s_lshl_b32 s43, s43, 12
  s_add_u32 s43, s43, 65536
  v_bfe_u32 v6, v1, 2, 2
  v_mul_u32_u24 v7, 8, v3
  v_add_u32 v7, v7, v6
  v_lshlrev_b32 v7, 7, v7
  v_and_b32 v8, 3, v1
  v_lshl_add_u32 v7, v8, 3, v7
  v_lshrrev_b32 v6, 1, v6
  v_and_b32 v8, 1, v3
  v_lshl_or_b32 v6, v8, 1, v6
  v_lshl_add_u32 v7, v6, 5, v7
  v_add_u32 v16, s43, v7
  v_xor_b32 v17, 32, v16
  v_xor_b32 v18, 64, v16
  v_xor_b32 v19, 0x60, v16
  s_waitcnt vmcnt(4)
  s_barrier
  ds_read_b64_tr_b16 v[32:33], v96 offset:0
  ds_read_b64_tr_b16 v[34:35], v96 offset:512
  ds_read_b64_tr_b16 v[48:49], v97 offset:0
  ds_read_b64_tr_b16 v[50:51], v97 offset:512
  ds_read_b64_tr_b16 v[36:37], v96 offset:1024
  ds_read_b64_tr_b16 v[38:39], v96 offset:1536
  ds_read_b64_tr_b16 v[52:53], v97 offset:1024
  ds_read_b64_tr_b16 v[54:55], v97 offset:1536
  ds_read_b64_tr_b16 v[100:101], v16 offset:0
  ds_read_b64_tr_b16 v[102:103], v16 offset:512
  ds_read_b64_tr_b16 v[104:105], v17 offset:0
  ds_read_b64_tr_b16 v[106:107], v17 offset:512
  ds_read_b64_tr_b16 v[108:109], v18 offset:0
  ds_read_b64_tr_b16 v[110:111], v18 offset:512
  ds_read_b64_tr_b16 v[112:113], v19 offset:0
  ds_read_b64_tr_b16 v[114:115], v19 offset:512
  s_cmp_ge_u32 s39, 4
  s_cbranch_scc1 L_14
  s_lshl_b32 s40, s39, 10
  s_add_u32 s40, s40, s63
  s_add_u32 s40, s40, 3145728
  s_add_u32 s41, s40, 32768
  s_lshl_b32 s4, s39, 15
  s_lshl_b32 s5, s57, 13
  s_add_u32 s4, s4, s5
  s_add_u32 s4, s4, 2104320
  s_add_u32 s5, s4, 524288
L_15:
  s_sub_u32 s56, s56, 1
  s_cbranch_scc1 L_abort
  s_and_b32 s100, s56, 255
  s_cbranch_scc1 L_16
  s_call_b64 s[100:101], L_repub
L_16:
  buffer_load_dwordx4 v[116:119], v191, s[44:47], s40 offen offset:0 sc1
  buffer_load_dwordx4 v[132:135], v191, s[44:47], s40 offen offset:512 sc1
  buffer_load_dwordx4 v[120:123], v191, s[44:47], s41 offen offset:0 sc1
  buffer_load_dwordx4 v[136:139], v191, s[44:47], s41 offen offset:512 sc1
  buffer_load_dwordx4 v[124:127], v191, s[44:47], s40 offen offset:256 sc1
  buffer_load_dwordx4 v[140:143], v191, s[44:47], s40 offen offset:768 sc1
  buffer_load_dwordx4 v[128:131], v191, s[44:47], s41 offen offset:256 sc1
  buffer_load_dwordx4 v[144:147], v191, s[44:47], s41 offen offset:768 sc1
  s_waitcnt vmcnt(7)
  v_mfma_f32_16x16x32_bf16 v[64:67], v[148:151], v[116:119], v[156:159]
  v_max3_u32 v6, v116, v117, v118
  v_max_u32 v6, v6, v119
  s_waitcnt vmcnt(6)
  v_mfma_f32_16x16x32_bf16 v[68:71], v[148:151], v[132:135], v[160:163]
  v_max3_u32 v6, v6, v132, v133
  v_max3_u32 v6, v6, v134, v135
  s_waitcnt vmcnt(5)
  v_mfma_f32_16x16x32_bf16 v[64:67], v[148:151], v[120:123], v[64:67]
  v_max3_u32 v6, v6, v120, v121
  v_max3_u32 v6, v6, v122, v123
  s_waitcnt vmcnt(4)
  v_mfma_f32_16x16x32_bf16 v[68:71], v[148:151], v[136:139], v[68:71]
  v_max3_u32 v6, v6, v136, v137
  v_max3_u32 v6, v6, v138, v139
  s_waitcnt vmcnt(3)
  v_mfma_f32_16x16x32_bf16 v[64:67], v[152:155], v[124:127], v[64:67]
  v_max3_u32 v6, v6, v124, v125
  v_max3_u32 v6, v6, v126, v127
  s_waitcnt vmcnt(2)
  v_mfma_f32_16x16x32_bf16 v[68:71], v[152:155], v[140:143], v[68:71]
  v_max3_u32 v6, v6, v140, v141
  v_max3_u32 v6, v6, v142, v143
  s_waitcnt vmcnt(1)
  v_mfma_f32_16x16x32_bf16 v[64:67], v[152:155], v[128:131], v[64:67]
  v_max3_u32 v6, v6, v128, v129
  v_max3_u32 v6, v6, v130, v131
  s_waitcnt vmcnt(0)
  v_mfma_f32_16x16x32_bf16 v[68:71], v[152:155], v[144:147], v[68:71]
  v_max3_u32 v6, v6, v144, v145
  v_max3_u32 v6, v6, v146, v147
  v_cmp_eq_u32 vcc, -1, v6
  s_cbranch_vccnz L_15
  v_pk_add_f32 v[6:7], v[64:65], v[66:67]
  v_pk_mul_f32 v[8:9], v[64:65], v[64:65]
  v_pk_fma_f32 v[8:9], v[66:67], v[66:67], v[8:9]
  s_cmp_gt_u32 s57, 1
  v_pk_add_f32 v[10:11], v[68:69], v[70:71]
  v_pk_fma_f32 v[8:9], v[68:69], v[68:69], v[8:9]
  v_pk_add_f32 v[6:7], v[6:7], v[10:11]
  v_pk_fma_f32 v[8:9], v[70:71], v[70:71], v[8:9]
  v_add_f32 v6, v6, v7
  v_add_f32 v8, v8, v9
  v_pk_mul_f32 v[72:73], v[64:65], v[180:181]
  v_add_f32_dpp v6, v6, v6 quad_perm:[1,0,3,2] row_mask:0xf bank_mask:0xf
  v_add_f32_dpp v8, v8, v8 quad_perm:[1,0,3,2] row_mask:0xf bank_mask:0xf
  v_pk_mul_f32 v[74:75], v[66:67], v[182:183]
  v_add_f32_dpp v6, v6, v6 quad_perm:[2,3,0,1] row_mask:0xf bank_mask:0xf
  v_add_f32_dpp v8, v8, v8 quad_perm:[2,3,0,1] row_mask:0xf bank_mask:0xf
  v_pk_mul_f32 v[76:77], v[68:69], v[184:185]
  v_add_f32_dpp v6, v6, v6 row_half_mirror row_mask:0xf bank_mask:0xf
  v_add_f32_dpp v8, v8, v8 row_half_mirror row_mask:0xf bank_mask:0xf
  v_pk_mul_f32 v[78:79], v[70:71], v[186:187]
  v_add_f32_dpp v6, v6, v6 row_mirror row_mask:0xf bank_mask:0xf
  v_add_f32_dpp v8, v8, v8 row_mirror row_mask:0xf bank_mask:0xf
  s_cbranch_scc1 L_17
  buffer_store_dwordx4 v[64:67], v192, s[44:47], s4 offen sc1
  buffer_store_dwordx4 v[68:71], v192, s[44:47], s5 offen sc1
L_17:
  s_nop 0
  v_permlane32_swap_b32 v6, v8
  v_add_f32 v6, v6, v8
  v_mul_f32 v7, 0x3b000000, v6
  v_mul_f32 v6, 0x3b000000, v6
  s_nop 1
  v_permlane16_swap_b32 v6, v7
  v_add_f32 v6, v6, v7
  s_nop 0
  v_readlane_b32 s58, v6, 0
  v_readlane_b32 s40, v6, 32
  s_mov_b32 s59, s58
  v_mov_b32 v7, s58
  v_fma_f32 v6, -v7, v7, s40
  v_max_f32 v6, 0, v6
  v_add_f32 v6, 0x3727c5ac, v6
  v_rsq_f32 v6, v6
  v_pk_fma_f32 v[72:73], v[180:181], s[58:59], v[72:73] neg_lo:[1,0,0] neg_hi:[1,0,0]
  v_pk_fma_f32 v[74:75], v[182:183], s[58:59], v[74:75] neg_lo:[1,0,0] neg_hi:[1,0,0]
  v_pk_fma_f32 v[76:77], v[184:185], s[58:59], v[76:77] neg_lo:[1,0,0] neg_hi:[1,0,0]
  v_pk_fma_f32 v[78:79], v[186:187], s[58:59], v[78:79] neg_lo:[1,0,0] neg_hi:[1,0,0]
  v_pk_fma_f32 v[72:73], v[72:73], v[6:7], v[172:173] op_sel_hi:[1,0,1]
  v_pk_fma_f32 v[74:75], v[74:75], v[6:7], v[174:175] op_sel_hi:[1,0,1]
  v_pk_fma_f32 v[76:77], v[76:77], v[6:7], v[176:177] op_sel_hi:[1,0,1]
  v_pk_fma_f32 v[78:79], v[78:79], v[6:7], v[178:179] op_sel_hi:[1,0,1]
  v_cvt_pk_bf16_f32 v10, v72, v73
  v_cvt_pk_bf16_f32 v11, v74, v75
  v_cvt_pk_bf16_f32 v12, v76, v77
  v_cvt_pk_bf16_f32 v13, v78, v79
  ds_write_b64 v189, v[10:11]
  ds_write_b64 v189, v[12:13] offset:512
  s_branch L_G3
L_14:
  s_waitcnt vmcnt(0)
L_G3:
  s_waitcnt lgkmcnt(0)
  s_barrier
  ds_read_b128 v[20:23], v193
  ds_read_b64_tr_b16 v[40:41], v96 offset:2048
  ds_read_b64_tr_b16 v[42:43], v96 offset:2560
  ds_read_b64_tr_b16 v[56:57], v97 offset:2048
  ds_read_b64_tr_b16 v[58:59], v97 offset:2560
  ds_read_b64_tr_b16 v[44:45], v96 offset:3072
  ds_read_b64_tr_b16 v[46:47], v96 offset:3584
  ds_read_b64_tr_b16 v[60:61], v97 offset:3072
  ds_read_b64_tr_b16 v[62:63], v97 offset:3584
  s_cmp_lg_u32 s39, 4
  s_cbranch_scc1 L_18
  buffer_store_dword v30, v200, s[44:47], s28 offen sc1
L_18:
  s_waitcnt lgkmcnt(8)
  v_mfma_f32_16x16x32_bf16 v[64:67], v[20:23], v[32:35], 0
  v_mfma_f32_16x16x32_bf16 v[80:83], v[20:23], v[48:51], 0
  v_mfma_f32_16x16x32_bf16 v[68:71], v[20:23], v[36:39], 0
  v_mfma_f32_16x16x32_bf16 v[84:87], v[20:23], v[52:55], 0
  s_waitcnt lgkmcnt(4)
  v_mfma_f32_16x16x32_bf16 v[72:75], v[20:23], v[40:43], 0
  v_mfma_f32_16x16x32_bf16 v[88:91], v[20:23], v[56:59], 0
  s_waitcnt lgkmcnt(0)
  v_mfma_f32_16x16x32_bf16 v[76:79], v[20:23], v[44:47], 0
  v_mfma_f32_16x16x32_bf16 v[92:95], v[20:23], v[60:63], 0
  s_nop 3
  v_add_f32 v6, v64, v69
  v_add_f32 v7, v80, v85
  v_add_f32 v6, v6, v74
  v_add_f32 v7, v7, v90
  v_add_f32 v6, v6, v79
  v_add_f32 v7, v7, v95
  ds_write2_b32 v194, v6, v7 offset0:0 offset1:32
  s_waitcnt lgkmcnt(0)
  s_barrier
  ds_read_b64 v[64:65], v195 offset:0
  ds_read_b64 v[68:69], v195 offset:1280
  ds_read_b64 v[72:73], v195 offset:2560
  ds_read_b64 v[76:77], v195 offset:3840
  ds_read_b64 v[66:67], v195 offset:128
  ds_read_b64 v[70:71], v195 offset:1408
  ds_read_b64 v[74:75], v195 offset:2688
  ds_read_b64 v[78:79], v195 offset:3968
  s_waitcnt lgkmcnt(4)
  v_pk_add_f32 v[64:65], v[64:65], v[68:69]
  v_pk_add_f32 v[72:73], v[72:73], v[76:77]
  v_pk_add_f32 v[64:65], v[64:65], v[72:73]
  v_mul_f32 v6, s62, v64
  v_mul_f32 v7, s62, v65
  v_exp_f32 v6, v6
  v_exp_f32 v7, v7
  s_waitcnt lgkmcnt(0)
  v_pk_add_f32 v[6:7], v[6:7], 1.0 op_sel_hi:[1,0]
  v_pk_add_f32 v[66:67], v[66:67], v[70:71]
  v_rcp_f32 v6, v6
  v_rcp_f32 v7, v7
  v_pk_add_f32 v[74:75], v[74:75], v[78:79]
  v_pk_mul_f32 v[64:65], v[64:65], v[6:7]
  v_pk_add_f32 v[66:67], v[66:67], v[74:75]
  v_pk_mul_f32 v[64:65], v[64:65], v[66:67]
  v_cvt_pk_bf16_f32 v6, v64, v65
  s_nop 1
  v_mov_b32_dpp v196, v6 quad_perm:[0,0,0,0] row_mask:0xf bank_mask:0xf
  v_mov_b32_dpp v197, v6 quad_perm:[1,1,1,1] row_mask:0xf bank_mask:0xf
  v_mov_b32_dpp v198, v6 quad_perm:[2,2,2,2] row_mask:0xf bank_mask:0xf
  v_mov_b32_dpp v199, v6 quad_perm:[3,3,3,3] row_mask:0xf bank_mask:0xf
  s_nop 1
  v_mfma_f32_16x16x32_bf16 v[80:83], v[196:199], v[100:103], 0
  v_mfma_f32_16x16x32_bf16 v[76:79], v[196:199], v[104:107], 0
  v_mfma_f32_16x16x32_bf16 v[72:75], v[196:199], v[108:111], 0
  v_mfma_f32_16x16x32_bf16 v[68:71], v[196:199], v[112:115], 0
  s_nop 5
  v_mov_b32 v81, v76
  v_mov_b32 v82, v72
  v_mov_b32 v83, v68
  buffer_store_dwordx4 v[80:83], v4, s[44:47], s6 offen sc1
  buffer_store_dwordx4 v[80:83], v4, s[44:47], s7 offen sc1
  s_branch L_done
L_Yspare:
  s_barrier
  s_add_u32 s57, s57, s38
  s_sub_u32 s57, s57, 7
  v_mov_b32 v64, -1
  v_mov_b32 v65, -1
  v_mov_b32 v66, -1
  v_mov_b32 v67, -1
  v_lshlrev_b32 v6, 4, v0
  v_lshlrev_b32 v7, 2, v1
  s_lshr_b32 s40, s57, 1
  s_lshl_b32 s40, s40, 2
  s_and_b32 s41, s57, 1
  s_add_u32 s40, s40, s41
  s_lshr_b32 s41, s39, 2
  s_add_u32 s40, s40, s41
  s_lshl_b32 s40, s40, 12
  s_add_u32 s40, s40, 3145728
  buffer_store_dwordx4 v[64:67], v6, s[44:47], s40 offen sc1
  s_waitcnt vmcnt(0)
  s_barrier
  s_cmp_lg_u32 s39, 0
  s_cbranch_scc1 L_19
  s_lshl_b32 s41, s57, 7
  s_add_u32 s41, s41, 4096
  s_mov_b32 exec_hi, 0
  buffer_store_dword v30, v7, s[44:47], s41 offen sc1
  s_mov_b32 exec_hi, -1
L_19:
  s_barrier
  s_cmp_lg_u32 s39, 2
  s_cbranch_scc1 L_done
  s_call_b64 s[100:101], L_repub
  s_branch L_done
L_roleX:
  s_mov_b32 s56, 0x40000
  s_sub_u32 s38, s38, 8
  v_lshrrev_b32 v6, 3, v1
  v_mul_u32_u24 v4, 8192, v6
  v_and_b32 v6, 7, v1
  v_bfe_u32 v7, v1, 4, 1
  v_lshlrev_b32 v7, 1, v7
  v_xor_b32 v6, v6, v7
  v_lshl_add_u32 v4, v6, 4, v4
  v_xor_b32 v5, 64, v4
  s_lshl_b32 s43, s39, 13
  s_mov_b32 m0, s43
  s_lshl_b32 s40, s39, 19
  s_lshl_b32 s41, s37, 10
  s_add_u32 s40, s40, s41
  s_lshl_b32 s41, s38, 7
  s_add_u32 s40, s40, s41
  s_waitcnt lgkmcnt(0)
  s_load_dword s36, s[34:35], 0
  s_mov_b32 s48, s14
  s_mov_b32 s49, s15
  s_mov_b32 s50, 0x400000
  s_mov_b32 s51, 0x20000
  buffer_load_dwordx4 v4, s[48:51], s40 offen nt lds
  s_add_u32 m0, m0, 1024
  s_add_u32 s40, s40, 65536
  s_mov_b32 s44, s34
  s_mov_b32 s45, s35
  s_mov_b32 s46, 0x400000
  s_mov_b32 s47, 0x20000
  v_mov_b32 v64, -1
  v_mov_b32 v65, -1
  v_mov_b32 v66, -1
  v_mov_b32 v67, -1
  v_lshlrev_b32 v6, 4, v0
  s_mul_i32 s41, s37, 40960
  s_mul_i32 s42, s38, 4224
  s_add_u32 s41, s41, s42
  s_add_u32 s41, s41, 196608
  v_cmp_gt_u32 vcc, 264, v0
  s_and_saveexec_b64 s[58:59], vcc
  s_cbranch_execz L_20
  buffer_store_dwordx4 v[64:67], v6, s[44:47], s41 offen sc1
L_20:
  s_mov_b64 exec, s[58:59]
  buffer_load_dwordx4 v4, s[48:51], s40 offen nt lds
  s_add_u32 m0, m0, 1024
  s_add_u32 s40, s40, 65536
  buffer_load_dwordx4 v5, s[48:51], s40 offen nt lds
  s_add_u32 m0, m0, 1024
  s_add_u32 s40, s40, 65536
  buffer_load_dwordx4 v5, s[48:51], s40 offen nt lds
  s_add_u32 m0, m0, 1024
  s_add_u32 s40, s40, 65536
  s_waitcnt vmcnt(3)
  buffer_load_dwordx4 v4, s[48:51], s40 offen nt lds
  s_add_u32 m0, m0, 1024
  s_add_u32 s40, s40, 65536
  s_waitcnt vmcnt(3)
  buffer_load_dwordx4 v4, s[48:51], s40 offen nt lds
  s_add_u32 m0, m0, 1024
  s_add_u32 s40, s40, 65536
  s_waitcnt vmcnt(3)
  buffer_load_dwordx4 v5, s[48:51], s40 offen nt lds
  s_add_u32 m0, m0, 1024
  s_add_u32 s40, s40, 65536
  s_waitcnt vmcnt(3)
  buffer_load_dwordx4 v5, s[48:51], s40 offen nt lds
  v_lshrrev_b32 v6, 3, v1
  v_lshlrev_b32 v142, 10, v6
  v_and_b32 v6, 7, v1
  v_bfe_u32 v7, v1, 4, 1
  v_lshlrev_b32 v7, 1, v7
  v_xor_b32 v6, v6, v7
  v_lshl_add_u32 v142, v6, 4, v142
  v_xor_b32 v143, 64, v142
  s_lshl_b32 s63, s37, 19
  s_lshl_b32 s43, s39, 16
  s_add_u32 s63, s63, s43
  s_lshl_b32 s43, s38, 7
  s_add_u32 s63, s63, s43
  s_mov_b32 s52, s16
  s_mov_b32 s53, s17
  s_mov_b32 s54, 0x400000
  s_mov_b32 s55, 0x20000
  v_lshlrev_b32 v102, 4, v1
  s_lshl_b32 s4, s39, 10
  s_add_u32 s4, s4, 3211264
  s_lshl_b32 s43, s39, 13
  v_bfe_u32 v6, v1, 2, 2
  v_mul_u32_u24 v7, 16, v3
  v_add_u32 v7, v7, v6
  v_lshlrev_b32 v7, 7, v7
  v_and_b32 v8, 3, v1
  v_lshl_add_u32 v7, v8, 3, v7
  v_lshrrev_b32 v6, 1, v6
  v_and_b32 v8, 1, v3
  v_lshl_or_b32 v6, v8, 1, v6
  v_lshl_add_u32 v7, v6, 5, v7
  v_add_u32 v16, s43, v7
  v_xor_b32 v17, 32, v16
  v_xor_b32 v18, 64, v16
  v_xor_b32 v19, 0x60, v16
  s_lshl_b32 s43, s39, 10
  s_add_u32 s43, s43, 135168
  v_lshlrev_b32 v28, 8, v3
  v_lshl_add_u32 v28, v2, 2, v28
  v_add_u32 v28, s43, v28
  v_lshlrev_b32 v29, 4, v1
  v_add_u32 v29, 135168, v29
  s_lshl_b32 s6, s37, 13
  s_lshl_b32 s41, s38, 8
  s_add_u32 s6, s6, s41
  s_add_u32 s6, s6, 65536
  s_add_u32 s7, s6, 65536
  v_lshlrev_b32 v104, 11, v3
  v_lshl_add_u32 v104, v2, 4, v104
  s_cmp_lg_u32 s39, 0
  s_cbranch_scc1 L_Xnt
  buffer_load_dword v31, v104, s[44:47], s6 offen sc1
L_Xnt:
  s_waitcnt lgkmcnt(0)
  s_add_u32 s36, s36, 0x9e3779b9
  v_mov_b32 v30, s36
  s_getreg_b32 s27, hwreg(HW_REG_XCC_ID, 2, 1)
  s_lshl_b32 s27, s27, 13
  s_xor_b32 s40, s27, 8192
  s_add_u32 s4, s4, s40
  s_lshl_b32 s40, s39, 2
  s_add_u32 s40, s40, 134912
  v_mov_b32 v103, s40
  s_waitcnt vmcnt(0)
  s_barrier
  buffer_load_dwordx4 v[96:99], v102, s[44:47], s4 offen sc1
  s_waitcnt vmcnt(1)
  ds_read_b64_tr_b16 v[32:33], v16 offset:0
  ds_read_b64_tr_b16 v[34:35], v16 offset:512
  ds_read_b64_tr_b16 v[40:41], v17 offset:0
  ds_read_b64_tr_b16 v[42:43], v17 offset:512
  ds_read_b64_tr_b16 v[48:49], v18 offset:0
  ds_read_b64_tr_b16 v[50:51], v18 offset:512
  ds_read_b64_tr_b16 v[56:57], v19 offset:0
  ds_read_b64_tr_b16 v[58:59], v19 offset:512
  ds_read_b64_tr_b16 v[36:37], v16 offset:1024
  ds_read_b64_tr_b16 v[38:39], v16 offset:1536
  ds_read_b64_tr_b16 v[44:45], v17 offset:1024
  ds_read_b64_tr_b16 v[46:47], v17 offset:1536
  ds_read_b64_tr_b16 v[52:53], v18 offset:1024
  ds_read_b64_tr_b16 v[54:55], v18 offset:1536
  ds_read_b64_tr_b16 v[60:61], v19 offset:1024
  ds_read_b64_tr_b16 v[62:63], v19 offset:1536
  s_branch L_22
L_21:
  s_sub_u32 s56, s56, 1
  s_cbranch_scc1 L_abort
  buffer_load_dwordx4 v[96:99], v102, s[44:47], s4 offen sc1
L_22:
  s_waitcnt vmcnt(0)
  v_bitop3_b32 v6, v97, v99, v30 bitop3:0x7e
  v_mov_b32 v20, v96
  v_mov_b32 v21, v98
  v_cmp_lt_u32 vcc, 1, v6
  v_mov_b32_dpp v22, v96 quad_perm:[1,1,3,3] row_mask:0xf bank_mask:0xf
  v_mov_b32_dpp v23, v98 quad_perm:[1,1,3,3] row_mask:0xf bank_mask:0xf
  s_cbranch_vccnz L_21
  s_waitcnt lgkmcnt(0)
  v_cmp_eq_u32 vcc, 1, v6
  s_bcnt1_i32_b64 s40, vcc
  v_mov_b32 v96, s40
  v_mfma_f32_16x16x32_bf16 v[64:67], v[20:23], v[32:35], 0
  v_mfma_f32_16x16x32_bf16 v[68:71], v[20:23], v[36:39], 0
  v_mfma_f32_16x16x32_bf16 v[72:75], v[20:23], v[40:43], 0
  v_mfma_f32_16x16x32_bf16 v[76:79], v[20:23], v[44:47], 0
  v_mfma_f32_16x16x32_bf16 v[80:83], v[20:23], v[48:51], 0
  v_mfma_f32_16x16x32_bf16 v[84:87], v[20:23], v[52:55], 0
  v_mfma_f32_16x16x32_bf16 v[88:91], v[20:23], v[56:59], 0
  v_mfma_f32_16x16x32_bf16 v[92:95], v[20:23], v[60:63], 0
  s_nop 1
  v_add_f32 v6, v64, v70
  s_nop 0
  v_add_f32 v7, v72, v78
  s_nop 0
  v_add_f32 v8, v80, v86
  s_nop 0
  v_add_f32 v9, v88, v94
  ds_write2_b32 v28, v6, v7 offset0:0 offset1:16
  ds_write2_b32 v28, v8, v9 offset0:32 offset1:48
  ds_write_b32 v103, v96
  s_waitcnt lgkmcnt(0)
  s_barrier
  s_cmp_lg_u32 s39, 0
  s_cbranch_scc1 L_23
  ds_read_b128 v[64:67], v29 offset:0
  ds_read_b128 v[68:71], v29 offset:1024
  ds_read_b128 v[72:75], v29 offset:2048
  ds_read_b128 v[76:79], v29 offset:3072
  ds_read_b128 v[80:83], v29 offset:4096
  ds_read_b128 v[84:87], v29 offset:5120
  ds_read_b128 v[88:91], v29 offset:6144
  ds_read_b128 v[92:95], v29 offset:7168
  s_waitcnt lgkmcnt(0)
  v_pk_add_f32 v[64:65], v[64:65], v[80:81]
  v_pk_add_f32 v[66:67], v[66:67], v[82:83]
  v_pk_add_f32 v[68:69], v[68:69], v[84:85]
  v_pk_add_f32 v[70:71], v[70:71], v[86:87]
  v_pk_add_f32 v[72:73], v[72:73], v[88:89]
  v_pk_add_f32 v[74:75], v[74:75], v[90:91]
  v_pk_add_f32 v[76:77], v[76:77], v[92:93]
  v_pk_add_f32 v[78:79], v[78:79], v[94:95]
  v_pk_add_f32 v[64:65], v[64:65], v[72:73]
  v_pk_add_f32 v[66:67], v[66:67], v[74:75]
  v_pk_add_f32 v[68:69], v[68:69], v[76:77]
  v_pk_add_f32 v[70:71], v[70:71], v[78:79]
  v_pk_add_f32 v[64:65], v[64:65], v[68:69]
  v_pk_add_f32 v[66:67], v[66:67], v[70:71]
  v_cvt_pk_bf16_f32 v10, v64, v65
  v_cvt_pk_bf16_f32 v12, v66, v67
  v_mov_b32 v11, v30
  v_mov_b32 v13, v30
  buffer_store_dwordx4 v[10:13], v104, s[44:47], s6 offen
L_23:
  v_mov_b32 v96, 134912
  ds_read_b128 v[72:75], v96
  ds_read_b128 v[76:79], v96 offset:16
  s_waitcnt lgkmcnt(0)
  v_add3_u32 v72, v72, v73, v74
  v_add3_u32 v75, v75, v76, v77
  v_add3_u32 v72, v72, v78, v79
  v_add_u32 v72, v72, v75
  v_cmp_lt_u32 vcc, 0x100, v72
  s_cmp_lg_u64 vcc, 0
  s_cselect_b32 s26, 8192, 0
  s_xor_b32 s26, s26, s27
  s_cmp_lg_u32 s39, 0
  s_cbranch_scc1 L_24
  s_lshr_b32 s40, s26, 13
  v_xor_b32 v11, s40, v30
  v_xor_b32 v13, s40, v30
  buffer_store_dwordx4 v[10:13], v104, s[44:47], s7 offen sc1
L_24:
  s_barrier
  s_cmp_lg_u32 s39, 1
  s_cbranch_scc1 L_25
  v_min_u32 v6, 16, v1
  v_lshlrev_b32 v6, 7, v6
  s_mul_i32 s40, s37, 40960
  s_mul_i32 s41, s38, 2176
  s_add_u32 s40, s40, s41
  s_add_u32 s40, s40, 196608
  buffer_load_dword v31, v6, s[44:47], s40 offen sc1
L_25:
  v_mov_b32 v64, -1
  v_mov_b32 v65, -1
  v_mov_b32 v66, -1
  v_mov_b32 v67, -1
  v_lshlrev_b32 v6, 4, v0
  s_lshl_b32 s40, s37, 3
  s_add_u32 s40, s40, s38
  s_lshl_b32 s40, s40, 14
  s_add_u32 s40, s40, s26
  s_add_u32 s40, s40, 2097152
  buffer_store_dwordx4 v[64:67], v6, s[44:47], s40 offen sc1
  s_lshl_b32 s43, s39, 13
  s_add_u32 m0, s43, 65536
  s_nop 0
  s_waitcnt vmcnt(3)
  buffer_load_dwordx4 v142, s[52:55], s63 offen nt lds
  s_add_u32 m0, m0, 0x400
  s_add_u32 s63, s63, 0x2000
  s_waitcnt vmcnt(3)
  buffer_load_dwordx4 v142, s[52:55], s63 offen nt lds
  s_add_u32 m0, m0, 0x400
  s_add_u32 s63, s63, 0x2000
  s_waitcnt vmcnt(3)
  buffer_load_dwordx4 v143, s[52:55], s63 offen nt lds
  s_add_u32 m0, m0, 0x400
  s_add_u32 s63, s63, 0x2000
  s_waitcnt vmcnt(3)
  buffer_load_dwordx4 v143, s[52:55], s63 offen nt lds
  s_add_u32 m0, m0, 0x400
  s_add_u32 s63, s63, 0x2000
  s_waitcnt vmcnt(3)
  buffer_load_dwordx4 v142, s[52:55], s63 offen nt lds
  s_add_u32 m0, m0, 0x400
  s_add_u32 s63, s63, 0x2000
  s_waitcnt vmcnt(3)
  buffer_load_dwordx4 v142, s[52:55], s63 offen nt lds
  s_add_u32 m0, m0, 0x400
  s_add_u32 s63, s63, 0x2000
  s_waitcnt vmcnt(3)
  buffer_load_dwordx4 v143, s[52:55], s63 offen nt lds
  s_add_u32 m0, m0, 0x400
  s_add_u32 s63, s63, 0x2000
  s_waitcnt vmcnt(3)
  buffer_load_dwordx4 v143, s[52:55], s63 offen nt lds
  s_cmp_lg_u32 s39, 6
  s_cbranch_scc1 L_27
  v_and_b32 v10, 7, v1
  v_lshlrev_b32 v10, 8, v10
  s_lshl_b32 s41, s37, 13
  s_add_u32 s41, s41, 65536
  s_add_u32 s42, s41, 65536
L_26:
  s_sub_u32 s56, s56, 1
  s_cbranch_scc1 L_abort
  s_bitcmp1_b32 s56, 9
  s_cselect_b32 s40, s41, s42
  buffer_load_dword v11, v10, s[44:47], s40 offen offset:4 sc1
  s_waitcnt vmcnt(0)
  v_xor_b32 v11, s36, v11
  v_cmp_lt_u32 vcc, 1, v11
  s_cbranch_vccnz L_26
L_27:
  s_cmp_lg_u32 s39, 7
  s_cbranch_scc1 L_X1
  v_mov_b32 v10, 0
  s_lshl_b32 s40, s37, 7
  s_add_u32 s40, s40, 4096
L_28:
  s_sub_u32 s56, s56, 1
  s_cbranch_scc1 L_abort
  buffer_load_dword v11, v10, s[44:47], s40 offen sc1
  s_waitcnt vmcnt(0)
  v_cmp_ne_u32 vcc, s36, v11
  s_cbranch_vccnz L_28
L_X1:
  v_add_u32 v16, 65536, v16
  v_add_u32 v17, 65536, v17
  v_add_u32 v18, 65536, v18
  v_add_u32 v19, 65536, v19
  v_lshlrev_b32 v139, 4, v1
  s_lshl_b32 s41, s39, 11
  v_add_u32 v136, s41, v139
  s_lshr_b32 s42, s39, 1
  s_lshl_b32 s42, s42, 6
  s_add_u32 s42, s42, 16384
  v_and_b32 v6, 3, v2
  v_lshlrev_b32 v137, 4, v3
  v_lshl_add_u32 v137, v6, 2, v137
  v_add_u32 v137, s42, v137
  s_mul_i32 s5, s37, 40960
  s_lshr_b32 s7, s37, 1
  s_lshl_b32 s7, s7, 14
  s_and_b32 s41, s37, 1
  s_lshl_b32 s41, s41, 12
  s_add_u32 s7, s7, s41
  s_lshl_b32 s41, s38, 7
  s_add_u32 s7, s7, s41
  s_xor_b32 s41, s26, 8192
  s_add_u32 s7, s7, s41
  s_add_u32 s7, s7, 3145728
  s_xor_b32 s4, s7, 8192
  s_add_u32 s5, s5, 196608
  s_add_u32 s6, s5, 16640
  s_and_b32 s41, s39, 3
  s_lshl_b32 s41, s41, 10
  v_lshlrev_b32 v138, 1, v1
  v_add_u32 v138, s41, v138
  v_lshlrev_b32 v140, 2, v138
  s_lshr_b32 s41, s41, 2
  s_add_u32 s41, s41, 135168
  v_lshlrev_b32 v29, 2, v1
  v_add_u32 v29, s41, v29
  s_lshl_b32 s62, s38, 9
  s_add_u32 s62, s62, 49152
  s_lshl_b32 s57, s37, 3
  s_add_u32 s57, s57, s38
  s_cmp_lt_u32 s39, 4
  s_cbranch_scc1 L_Y2
  s_waitcnt vmcnt(0)
  buffer_load_dwordx2 v[108:109], v140, s[44:47], s62 offen sc1
  s_branch L_Y3
L_Y2:
  s_waitcnt vmcnt(0)
L_Y3:
  ds_read_b64_tr_b16 v[32:33], v16 offset:0
  ds_read_b64_tr_b16 v[34:35], v16 offset:512
  ds_read_b64_tr_b16 v[40:41], v17 offset:0
  ds_read_b64_tr_b16 v[42:43], v17 offset:512
  ds_read_b64_tr_b16 v[48:49], v18 offset:0
  ds_read_b64_tr_b16 v[50:51], v18 offset:512
  ds_read_b64_tr_b16 v[56:57], v19 offset:0
  ds_read_b64_tr_b16 v[58:59], v19 offset:512
  ds_read_b64_tr_b16 v[36:37], v16 offset:1024
  ds_read_b64_tr_b16 v[38:39], v16 offset:1536
  ds_read_b64_tr_b16 v[44:45], v17 offset:1024
  ds_read_b64_tr_b16 v[46:47], v17 offset:1536
  ds_read_b64_tr_b16 v[52:53], v18 offset:1024
  ds_read_b64_tr_b16 v[54:55], v18 offset:1536
  ds_read_b64_tr_b16 v[60:61], v19 offset:1024
  ds_read_b64_tr_b16 v[62:63], v19 offset:1536
  s_waitcnt lgkmcnt(0)
  s_barrier
L_29:
  s_sub_u32 s56, s56, 1
  s_cbranch_scc1 L_abort
  s_bitcmp1_b32 s56, 9
  s_cselect_b32 s40, s5, s6
  buffer_load_dword v104, v137, s[44:47], s40 offen sc1
  buffer_load_dwordx4 v[20:23], v136, s[44:47], s40 offen sc1
  buffer_load_dwordx4 v[24:27], v136, s[44:47], s40 offen offset:1024 sc1
  s_waitcnt vmcnt(1)
  v_mfma_f32_16x16x32_bf16 v[64:67], v[20:23], v[32:35], 0
  v_max_f32_dpp v105, v104, v104 quad_perm:[1,0,3,2] row_mask:0xf bank_mask:0xf
  v_max3_u32 v6, v20, v21, v22
  v_mfma_f32_16x16x32_bf16 v[68:71], v[20:23], v[40:43], 0
  v_max_f32_dpp v105, v105, v105 quad_perm:[2,3,0,1] row_mask:0xf bank_mask:0xf
  v_max3_u32 v6, v6, v23, v104
  v_mfma_f32_16x16x32_bf16 v[72:75], v[20:23], v[48:51], 0
  v_sub_f32 v105, v104, v105
  v_exp_f32 v105, v105
  v_mfma_f32_16x16x32_bf16 v[76:79], v[20:23], v[56:59], 0
  s_waitcnt vmcnt(0)
  v_max3_u32 v6, v6, v24, v25
  v_max3_u32 v6, v6, v26, v27
  v_mfma_f32_16x16x32_bf16 v[64:67], v[24:27], v[36:39], v[64:67]
  v_cmp_eq_u32 vcc, -1, v6
  v_add_f32_dpp v106, v105, v105 quad_perm:[1,0,3,2] row_mask:0xf bank_mask:0xf
  s_cbranch_vccnz L_29
  v_mfma_f32_16x16x32_bf16 v[68:71], v[24:27], v[44:47], v[68:71]
  v_add_f32_dpp v106, v106, v106 quad_perm:[2,3,0,1] row_mask:0xf bank_mask:0xf
  v_rcp_f32 v106, v106
  v_mfma_f32_16x16x32_bf16 v[72:75], v[24:27], v[52:55], v[72:75]
  v_mul_f32 v105, v105, v106
  s_nop 0
  v_mfma_f32_16x16x32_bf16 v[76:79], v[24:27], v[60:63], v[76:79]
  v_mov_b32_dpp v100, v105 quad_perm:[0,0,0,0] row_mask:0xf bank_mask:0xf
  v_mov_b32_dpp v101, v105 quad_perm:[1,1,1,1] row_mask:0xf bank_mask:0xf
  v_mov_b32_dpp v102, v105 quad_perm:[2,2,2,2] row_mask:0xf bank_mask:0xf
  v_mov_b32_dpp v103, v105 quad_perm:[3,3,3,3] row_mask:0xf bank_mask:0xf
  v_pk_mul_f32 v[64:65], v[64:65], v[100:101]
  v_pk_fma_f32 v[64:65], v[66:67], v[102:103], v[64:65]
  v_add_f32 v6, v64, v65
  v_pk_mul_f32 v[68:69], v[68:69], v[100:101]
  v_pk_fma_f32 v[68:69], v[70:71], v[102:103], v[68:69]
  v_add_f32 v7, v68, v69
  ds_write2_b32 v28, v6, v7 offset0:0 offset1:16
  v_pk_mul_f32 v[72:73], v[72:73], v[100:101]
  v_pk_fma_f32 v[72:73], v[74:75], v[102:103], v[72:73]
  v_add_f32 v8, v72, v73
  v_pk_mul_f32 v[76:77], v[76:77], v[100:101]
  v_pk_fma_f32 v[76:77], v[78:79], v[102:103], v[76:77]
  v_add_f32 v9, v76, v77
  ds_write2_b32 v28, v8, v9 offset0:32 offset1:48
  v_xor_b32 v12, v109, v30
  s_cmp_lt_u32 s39, 4
  v_cmp_lt_u32 vcc, 1, v12
  s_waitcnt lgkmcnt(0)
  s_barrier
  s_cbranch_scc1 L_Wlow
  ds_read2st64_b32 v[64:65], v29 offset0:0 offset1:4
  ds_read2st64_b32 v[66:67], v29 offset0:8 offset1:12
  ds_read2st64_b32 v[68:69], v29 offset0:16 offset1:20
  ds_read2st64_b32 v[70:71], v29 offset0:24 offset1:28
  s_cbranch_vccnz L_30
L_31:
  v_lshlrev_b32 v108, 16, v108
  s_mov_b32 s58, 0x55555555
  s_mov_b32 s59, 0x55555555
  s_waitcnt lgkmcnt(2)
  v_add_f32 v64, v64, v65
  v_add_f32 v66, v66, v67
  s_waitcnt lgkmcnt(0)
  v_add_f32 v68, v68, v69
  v_add_f32 v70, v70, v71
  v_add_f32 v64, v64, v66
  v_add_f32 v68, v68, v70
  v_add_f32 v64, v64, v68
  v_mul_f32 v64, v64, v108
  s_nop 1
  v_mov_b32_dpp v65, v64 quad_perm:[1,1,3,3] row_mask:0xf bank_mask:0xf
  v_cvt_pk_bf16_f32 v10, v64, v65
  v_min_u32 v10, -2, v10
  s_mov_b64 exec, s[58:59]
  buffer_store_dword v10, v138, s[44:47], s7 offen sc1
  buffer_store_dword v10, v138, s[44:47], s4 offen sc1
  s_barrier
  s_branch L_done
L_30:
  s_sub_u32 s56, s56, 1
  s_cbranch_scc1 L_abort
  buffer_load_dwordx2 v[108:109], v140, s[44:47], s62 offen sc1
  s_waitcnt vmcnt(0)
  v_xor_b32 v12, v109, v30
  v_cmp_lt_u32 vcc, 1, v12
  s_cbranch_vccnz L_30
  s_branch L_31
L_Wlow:
  s_cmp_lg_u32 s39, 1
  s_cbranch_scc1 L_done
L_F:
  v_and_b32 v6, 1, v3
  v_lshrrev_b32 v7, 1, v3
  v_lshl_or_b32 v96, v6, 1, v7
  v_and_b32 v6, 7, v1
  v_lshlrev_b32 v97, 2, v6
  v_lshl_add_u32 v97, v96, 5, v97
  s_lshl_b32 s40, s37, 6
  s_and_b32 s41, s38, 1
  s_lshl_b32 s41, s41, 3
  s_add_u32 s40, s40, s41
  s_lshr_b32 s41, s38, 1
  s_lshl_b32 s41, s41, 9
  s_add_u32 s40, s40, s41
  v_lshl_add_u32 v7, v96, 4, v6
  v_add_u32 v7, s40, v7
  v_lshlrev_b32 v136, 1, v7
  v_lshlrev_b32 v8, 2, v136
  s_barrier
  s_mov_b32 s40, 49152
L_32:
  s_sub_u32 s56, s56, 1
  s_cbranch_scc1 L_abort
  buffer_load_dwordx2 v[98:99], v8, s[44:47], s40 offen sc1
  s_waitcnt vmcnt(0)
  v_xor_b32 v99, s36, v99
  v_cmp_lt_u32 vcc, 1, v99
  s_cbranch_vccnz L_32
  v_and_b32 v98, 0xffff0000, v98
  s_lshl_b32 s40, s57, 14
  s_add_u32 s40, s40, s26
  s_add_u32 s40, s40, 2097152
  s_add_u32 s41, s40, 4096
  v_min_u32 v6, 55, v1
  v_lshlrev_b32 v6, 7, v6
  s_add_u32 s42, s26, 3227648
L_33:
  s_sub_u32 s56, s56, 1
  s_cbranch_scc1 L_abort
  buffer_load_dword v10, v6, s[44:47], s42 offen sc1
  s_waitcnt vmcnt(0)
  v_cmp_ne_u32 vcc, v10, v30
  s_cbranch_vccnz L_33
L_34:
L_35:
  s_sub_u32 s56, s56, 1
  s_cbranch_scc1 L_abort
  buffer_load_dwordx4 v[100:103], v139, s[44:47], s40 offen offset:0 sc1
  buffer_load_dwordx4 v[104:107], v139, s[44:47], s40 offen offset:1024 sc1
  buffer_load_dwordx4 v[108:111], v139, s[44:47], s40 offen offset:2048 sc1
  buffer_load_dwordx4 v[112:115], v139, s[44:47], s40 offen offset:3072 sc1
  buffer_load_dwordx4 v[116:119], v139, s[44:47], s41 offen offset:0 sc1
  buffer_load_dwordx4 v[120:123], v139, s[44:47], s41 offen offset:1024 sc1
  buffer_load_dwordx4 v[124:127], v139, s[44:47], s41 offen offset:2048 sc1
  buffer_load_dword v128, v97, s[44:47], s41 offen offset:3072 sc1
  s_waitcnt vmcnt(6)
  v_pk_add_f32 v[64:65], v[100:101], v[104:105]
  v_pk_add_f32 v[66:67], v[102:103], v[106:107]
  s_waitcnt vmcnt(5)
  v_pk_add_f32 v[64:65], v[64:65], v[108:109]
  v_pk_add_f32 v[66:67], v[66:67], v[110:111]
  s_waitcnt vmcnt(4)
  v_pk_add_f32 v[64:65], v[64:65], v[112:113]
  v_pk_add_f32 v[66:67], v[66:67], v[114:115]
  s_waitcnt vmcnt(3)
  v_pk_add_f32 v[64:65], v[64:65], v[116:117]
  v_pk_add_f32 v[66:67], v[66:67], v[118:119]
  s_waitcnt vmcnt(2)
  v_pk_add_f32 v[64:65], v[64:65], v[120:121]
  v_pk_add_f32 v[66:67], v[66:67], v[122:123]
  s_waitcnt vmcnt(1)
  v_pk_add_f32 v[64:65], v[64:65], v[124:125]
  v_pk_add_f32 v[66:67], v[66:67], v[126:127]
  s_nop 0
  v_permlane32_swap_b32 v64, v65
  v_permlane32_swap_b32 v66, v67
  v_add_f32 v64, v64, v65
  v_add_f32 v66, v66, v67
  s_nop 1
  v_permlane16_swap_b32 v64, v66
  v_add_f32 v64, v64, v66
  s_waitcnt vmcnt(0)
  s_nop 0
  v_add_f32_dpp v64, v64, v64 row_ror:8 row_mask:0xf bank_mask:0xf
  v_fma_f32 v6, v64, v98, v128
  v_cmp_u_f32 vcc, v6, v6
  v_cvt_pk_bf16_f32 v6, v6, v6
  s_cbranch_vccz L_36
  s_and_b32 s42, s56, 63
  s_cbranch_scc1 L_35
  v_max3_u32 v8, v100, v101, v102
  v_max3_u32 v9, v103, v104, v105
  v_max3_u32 v8, v8, v106, v107
  v_max3_u32 v9, v9, v108, v109
  v_max3_u32 v8, v8, v110, v111
  v_max3_u32 v9, v9, v112, v113
  v_max3_u32 v8, v8, v114, v115
  v_max3_u32 v9, v9, v116, v117
  v_max3_u32 v8, v8, v118, v119
  v_max3_u32 v9, v9, v120, v121
  v_max3_u32 v8, v8, v122, v123
  v_max3_u32 v9, v9, v124, v125
  v_max3_u32 v8, v8, v126, v127
  v_max3_u32 v8, v8, v9, v128
  v_cmp_eq_u32 vcc, -1, v8
  s_cbranch_vccnz L_35
L_36:
  s_nop 0
  global_store_short v136, v6, s[30:31]
  s_cmp_lg_u32 s57, 0
  s_cbranch_scc1 L_done
  v_mov_b32 v7, 0
  v_mov_b32 v8, s36
  buffer_store_dword v8, v7, s[44:47], 0 offen offset:0 sc1
  s_branch L_done
L_roleA:
  s_cmp_ge_u32 s38, 32
  s_cbranch_scc1 L_end
  s_sub_u32 s38, s38, 16
  s_lshr_b32 s40, s38, 2
  s_lshl_b32 s40, s40, 3
  s_add_u32 s40, s40, s37
  s_and_b32 s42, s40, 8
  s_bcnt1_i32_b32 s42, s42
  s_and_b32 s42, s42, 1
  s_lshl_b32 s42, s42, 13
  s_lshl_b32 s62, s40, 20
  s_add_u32 s62, s62, s42
  s_lshl_b32 s42, s42, 1
  s_sub_u32 s100, -54784, s42
  s_lshl_b32 s43, s39, 13
  s_bitcmp1_b32 s39, 0
  s_cselect_b32 s41, 2048, 0
  s_add_u32 s62, s62, s41
  s_bitcmp1_b32 s39, 1
  s_cselect_b32 s41, 1024, 0
  s_add_u32 s62, s62, s41
  s_bitcmp1_b32 s39, 2
  s_cselect_b32 s41, 131072, 0
  s_add_u32 s62, s62, s41
  s_bitcmp1_b32 s38, 0
  s_cselect_b32 s41, 16384, 0
  s_add_u32 s62, s62, s41
  s_bitcmp1_b32 s38, 1
  s_cselect_b32 s41, 4096, 0
  s_add_u32 s62, s62, s41
  s_add_u32 s62, s62, 786432
  s_mov_b32 s63, s62
  v_and_b32 v6, 1, v3
  v_lshlrev_b32 v5, 15, v6
  v_lshrrev_b32 v6, 1, v3
  v_lshl_add_u32 v5, v6, 8, v5
  v_xor_b32 v6, v3, v2
  v_lshl_add_u32 v176, v6, 4, v5
  v_xor_b32 v177, 64, v176
  v_xor_b32 v178, 0x80, v176
  v_xor_b32 v179, 0xc0, v176
  s_add_u32 m0, s43, 65536
  s_mov_b32 s54, 33554432
  s_mov_b32 s55, 0x20000
  s_waitcnt lgkmcnt(0)
  s_mov_b32 s52, s10
  s_mov_b32 s53, s11
  buffer_load_dwordx4 v176, s[52:55], s62 offen offset:0 nt lds
  s_add_u32 s62, s62, 0xfffffe00
  buffer_load_dwordx4 v177, s[52:55], s62 offen offset:1024 nt lds
  s_add_u32 s62, s62, 0xfa00
  buffer_load_dwordx4 v178, s[52:55], s62 offen offset:2048 nt lds
  s_add_u32 s62, s62, 0xfffffe00
  buffer_load_dwordx4 v179, s[52:55], s62 offen offset:3072 nt lds
  s_load_dword s36, s[34:35], 0
  s_mov_b32 s48, s12
  s_mov_b32 s49, s13
  s_mov_b32 s50, 0x2000000
  s_mov_b32 s51, 0x20000
  s_mov_b32 s44, s34
  s_mov_b32 s45, s35
  s_mov_b32 s46, 0x400000
  s_mov_b32 s47, 0x20000
  s_mov_b32 s56, 0x40000
  v_lshlrev_b32 v6, 1, v3
  v_xor_b32 v8, v6, v2
  v_lshl_add_u32 v4, v8, 4, v5
  v_xor_b32 v5, 0x80, v4
  v_lshlrev_b32 v153, 8, v2
  v_lshl_add_u32 v153, v8, 4, v153
  s_add_u32 s41, s43, 65536
  v_add_u32 v153, s41, v153
  v_xor_b32 v154, 16, v153
  v_xor_b32 v155, 0x80, v153
  v_xor_b32 v156, 0x90, v153
  v_lshrrev_b32 v6, 2, v2
  v_and_b32 v7, 3, v2
  v_lshlrev_b32 v152, 4, v0
  s_lshl_b32 s40, s37, 13
  s_lshr_b32 s41, s38, 2
  s_lshl_b32 s41, s41, 11
  s_add_u32 s40, s40, s41
  s_add_u32 s4, s40, 65536
  s_add_u32 s5, s4, 65536
  v_lshrrev_b32 v8, 5, v0
  v_mul_u32_u24 v164, 272, v8
  v_and_b32 v8, 31, v0
  v_lshl_add_u32 v164, v8, 3, v164
  v_add_u32 v164, 133632, v164
  v_mul_u32_u24 v165, 272, v6
  v_lshl_add_u32 v165, v3, 5, v165
  v_add_u32 v165, 133632, v165
  v_lshrrev_b32 v8, 2, v1
  v_and_b32 v9, 7, v8
  v_xor_b32 v9, s39, v9
  v_lshlrev_b32 v157, 8, v8
  v_lshl_add_u32 v157, v9, 5, v157
  v_lshl_add_u32 v157, v7, 3, v157
  s_lshr_b32 s41, s39, 2
  s_lshl_b32 s41, s41, 10
  s_and_b32 s42, s39, 3
  s_lshl_b32 s42, s42, 4
  s_add_u32 s41, s41, s42
  s_add_u32 s41, s41, 131072
  v_lshlrev_b32 v158, 8, v3
  v_lshl_add_u32 v158, v6, 6, v158
  v_lshl_add_u32 v158, v7, 2, v158
  v_add_u32 v158, s41, v158
  v_lshlrev_b32 v159, 4, v1
  v_add_u32 v159, 131072, v159
  s_lshl_b32 s41, s39, 3
  s_add_u32 s41, s41, 133120
  v_lshlrev_b32 v160, 6, v6
  v_add_u32 v160, s41, v160
  v_and_b32 v8, 7, v2
  v_lshlrev_b32 v161, 6, v3
  v_lshl_add_u32 v161, v8, 3, v161
  v_add_u32 v161, 133120, v161
  v_lshlrev_b32 v162, 12, v3
  v_lshl_add_u32 v162, v8, 1, v162
  v_lshrrev_b32 v8, 3, v2
  v_lshl_add_u32 v162, v8, 10, v162
  s_lshr_b32 s41, s39, 2
  s_lshl_b32 s41, s41, 11
  s_and_b32 s42, s39, 3
  s_lshl_b32 s42, s42, 8
  s_add_u32 s41, s41, s42
  s_lshl_b32 s42, s38, 4
  s_add_u32 s41, s41, s42
  v_add_u32 v162, s41, v162
  s_lshl_b32 s41, s38, 2
  s_add_u32 s41, s41, 16384
  v_lshlrev_b32 v163, 6, v3
  v_add_u32 v163, s41, v163
  s_mul_i32 s6, s37, 40960
  s_add_u32 s6, s6, 196608
  s_add_u32 s7, s6, 16640
  s_bitcmp1_b32 s39, 0
  s_cselect_b32 s8, s22, s20
  s_cselect_b32 s9, s23, s21
  s_cmp_lt_u32 s39, 4
  s_cselect_b32 s41, 0, 0
  s_xor_b32 s41, s41, s38
  s_lshl_b32 s41, s41, 1
  s_bfe_u32 s42, s39, 0x10001
  s_xor_b32 s42, s42, 0
  s_add_u32 s41, s41, s42
  s_mul_i32 s41, s41, 57344
  s_and_b32 s40, s37, 3
  s_lshl_b32 s40, s40, 1
  s_lshr_b32 s42, s37, 2
  s_xor_b32 s42, s42, 1
  s_add_u32 s40, s40, s42
  s_lshr_b32 s42, s40, 1
  s_mul_i32 s42, s42, 896
  s_add_u32 s41, s41, s42
  s_and_b32 s42, s40, 1
  s_lshl_b32 s40, s42, 9
  s_add_u32 s41, s41, s40
  s_sub_u32 s42, 3, s42
  v_lshrrev_b32 v8, 2, v1
  v_mul_u32_u24 v166, 3584, v8
  v_min_u32 v8, s42, v7
  v_lshl_add_u32 v166, v8, 7, v166
  v_add_u32 v166, s41, v166
  v_and_b32 v8, 1, v2
  v_cmp_eq_u32 s[58:59], 1, v8
  v_and_b32 v8, 2, v2
  v_cmp_eq_u32 s[60:61], 2, v8
  s_cmp_eq_u32 s39, 0
  v_cndmask_b32 v162, v162, v163, s[58:59]
  s_cselect_b32 s57, 0x00020002, 0
  s_or_b32 s57, s57, 0x55555555
  s_waitcnt lgkmcnt(0)
  s_add_u32 s36, s36, 0x9e3779b9
  v_mov_b32 v30, s36
  s_add_u32 m0, m0, 4096
  s_add_u32 s62, s62, s100
  s_waitcnt vmcnt(3)
  buffer_load_dwordx4 v176, s[52:55], s62 offen offset:0 nt lds
  s_add_u32 s62, s62, 0xfffffe00
  s_waitcnt vmcnt(3)
  buffer_load_dwordx4 v177, s[52:55], s62 offen offset:1024 nt lds
  s_add_u32 s62, s62, 0xfa00
  s_waitcnt vmcnt(3)
  buffer_load_dwordx4 v178, s[52:55], s62 offen offset:2048 nt lds
  s_add_u32 s62, s62, 0xfffffe00
  s_waitcnt vmcnt(3)
  buffer_load_dwordx4 v179, s[52:55], s62 offen offset:3072 nt lds
  s_mov_b32 m0, s43
  s_nop 0
  s_waitcnt vmcnt(3)
  buffer_load_dwordx4 v4, s[48:51], s63 offen offset:0 nt lds
  s_add_u32 s63, s63, 0xfffffe00
  s_waitcnt vmcnt(3)
  buffer_load_dwordx4 v5, s[48:51], s63 offen offset:1024 nt lds
  s_add_u32 s63, s63, 0xfa00
  s_waitcnt vmcnt(3)
  buffer_load_dwordx4 v4, s[48:51], s63 offen offset:2048 nt lds
  s_add_u32 s63, s63, 0xfffffe00
  s_waitcnt vmcnt(3)
  buffer_load_dwordx4 v5, s[48:51], s63 offen offset:3072 nt lds
  s_add_u32 m0, m0, 4096
  s_add_u32 s63, s63, s100
  s_waitcnt vmcnt(3)
  buffer_load_dwordx4 v4, s[48:51], s63 offen offset:0 nt lds
  s_add_u32 s63, s63, 0xfffffe00
  s_waitcnt vmcnt(3)
  buffer_load_dwordx4 v5, s[48:51], s63 offen offset:1024 nt lds
  s_add_u32 s63, s63, 0xfa00
  s_cmp_lt_u32 s39, 2
  s_cbranch_scc1 L_Aq
  s_waitcnt vmcnt(3)
  buffer_load_dwordx4 v4, s[48:51], s63 offen offset:2048 nt lds
  s_add_u32 s63, s63, 0xfffffe00
  s_waitcnt vmcnt(3)
  buffer_load_dwordx4 v5, s[48:51], s63 offen offset:3072 nt lds
  ds_read_b128 v[96:99], v153 offset:0
  ds_read_b128 v[112:115], v153 offset:4096
  ds_read_b128 v[100:103], v154 offset:0
  ds_read_b128 v[116:119], v154 offset:4096
  ds_read_b128 v[104:107], v155 offset:0
  ds_read_b128 v[120:123], v155 offset:4096
  ds_read_b128 v[108:111], v156 offset:0
  ds_read_b128 v[124:127], v156 offset:4096
  s_branch L_Abar
L_Aq:
  buffer_load_dwordx4 v[136:139], v152, s[44:47], s4 offen sc1
  s_waitcnt vmcnt(4)
  buffer_load_dwordx4 v4, s[48:51], s63 offen offset:2048 nt lds
  s_add_u32 s63, s63, 0xfffffe00
  buffer_load_dwordx4 v[140:143], v152, s[44:47], s4 offen sc1
  s_waitcnt vmcnt(5)
  buffer_load_dwordx4 v5, s[48:51], s63 offen offset:3072 nt lds
  buffer_load_dwordx4 v[144:147], v152, s[44:47], s4 offen sc1
  ds_read_b128 v[96:99], v153 offset:0
  ds_read_b128 v[112:115], v153 offset:4096
  ds_read_b128 v[100:103], v154 offset:0
  ds_read_b128 v[116:119], v154 offset:4096
  ds_read_b128 v[104:107], v155 offset:0
  ds_read_b128 v[120:123], v155 offset:4096
  ds_read_b128 v[108:111], v156 offset:0
  ds_read_b128 v[124:127], v156 offset:4096
  s_waitcnt vmcnt(4)
  v_bitop3_b32 v6, v137, v139, v30 bitop3:0x7e
  v_mov_b32 v128, v136
  v_mov_b32 v129, v138

  v_cmp_ne_u32 vcc, 0, v6
  s_cbranch_vccz L_Aqok
  s_waitcnt vmcnt(2)
  v_bitop3_b32 v6, v141, v143, v30 bitop3:0x7e
  v_mov_b32 v128, v140
  v_mov_b32 v129, v142

  v_cmp_ne_u32 vcc, 0, v6
  s_cbranch_vccz L_Aqok
  s_waitcnt vmcnt(0)
  v_bitop3_b32 v6, v145, v147, v30 bitop3:0x7e
  v_mov_b32 v128, v144
  v_mov_b32 v129, v146

  v_cmp_ne_u32 vcc, 0, v6
  s_cbranch_vccz L_Aqok
L_37:
  s_sub_u32 s56, s56, 1
  s_cbranch_scc1 L_abort
  s_bitcmp1_b32 s56, 9
  s_cselect_b32 s41, s4, s5
  buffer_load_dwordx4 v[128:131], v152, s[44:47], s41 offen sc1
  s_waitcnt vmcnt(0)
  v_bitop3_b32 v6, v129, v131, v30 bitop3:0x7e
  v_mov_b32 v129, v130
  v_cmp_lt_u32 vcc, 1, v6
  s_cbranch_vccnz L_37
L_Aqok:
  ds_write_b64 v164, v[128:129]
L_Abar:
  s_mov_b32 s16, s63
  s_mov_b32 s62, 0x3db504f3
  s_mov_b32 s63, 0x3fb8aa3b
  s_waitcnt lgkmcnt(0)
  s_barrier
  ds_read_b128 v[184:187], v165 offset:0
  ds_read_b128 v[188:191], v165 offset:16
  ds_read_b128 v[192:195], v165 offset:128
  ds_read_b128 v[196:199], v165 offset:144
  s_sub_u32 s40, s39, 4
  s_cmp_ge_u32 s40, 2
  s_cbranch_scc1 L_38
  global_load_dword v31, v166, s[8:9]
L_38:
  ds_read_b64_tr_b16 v[32:33], v157 offset:0
  ds_read_b64_tr_b16 v[36:37], v157 offset:8192
  ds_read_b64_tr_b16 v[40:41], v157 offset:16384
  ds_read_b64_tr_b16 v[44:45], v157 offset:24576
  ds_read_b64_tr_b16 v[48:49], v157 offset:32768
  ds_read_b64_tr_b16 v[52:53], v157 offset:40960
  ds_read_b64_tr_b16 v[56:57], v157 offset:49152
  ds_read_b64_tr_b16 v[60:61], v157 offset:57344
  s_waitcnt lgkmcnt(8)
  v_mfma_f32_16x16x32_bf16 v[64:67], v[96:99], v[184:187], 0
  v_mfma_f32_16x16x32_bf16 v[68:71], v[112:115], v[184:187], 0
  v_mfma_f32_16x16x32_bf16 v[64:67], v[100:103], v[188:191], v[64:67]
  v_mfma_f32_16x16x32_bf16 v[68:71], v[116:119], v[188:191], v[68:71]
  v_mfma_f32_16x16x32_bf16 v[64:67], v[104:107], v[192:195], v[64:67]
  v_mfma_f32_16x16x32_bf16 v[68:71], v[120:123], v[192:195], v[68:71]
  v_mfma_f32_16x16x32_bf16 v[64:67], v[108:111], v[196:199], v[64:67]
  v_mfma_f32_16x16x32_bf16 v[68:71], v[124:127], v[196:199], v[68:71]
  s_nop 6
  v_cndmask_b32 v6, v64, v66, s[58:59]
  v_cndmask_b32 v7, v65, v67, s[58:59]
  v_cndmask_b32 v8, v68, v70, s[58:59]
  v_cndmask_b32 v9, v69, v71, s[58:59]
  v_cndmask_b32 v6, v6, v8, s[60:61]
  v_cndmask_b32 v7, v7, v9, s[60:61]
  v_cvt_pk_bf16_f32 v8, v6, v7
  v_lshlrev_b32 v6, 16, v8
  v_and_b32 v7, 0xffff0000, v8
  v_mul_f32 v6, s62, v6
  v_mul_f32 v7, s62, v7
  v_cvt_pk_bf16_f32 v8, v6, v7
  v_lshlrev_b32 v6, 16, v8
  v_and_b32 v7, 0xffff0000, v8
  v_max_f32 v8, v6, v7
  s_nop 1
  v_max_f32_dpp v8, v8, v8 quad_perm:[1,0,3,2] row_mask:0xf bank_mask:0xf
  s_nop 1
  v_max_f32_dpp v8, v8, v8 quad_perm:[2,3,0,1] row_mask:0xf bank_mask:0xf
  v_mov_b32 v9, v8
  s_nop 1
  v_permlane16_swap_b32 v8, v9
  v_max_f32 v8, v8, v9
  v_mov_b32 v9, v8
  s_nop 1
  v_permlane32_swap_b32 v8, v9
  v_max_f32 v8, v8, v9
  v_mul_f32 v8, s63, v8
  v_fma_f32 v6, v6, s63, -v8
  v_fma_f32 v7, v7, s63, -v8
  v_exp_f32 v6, v6
  v_exp_f32 v7, v7
  s_nop 0
  v_add_f32 v9, v6, v7
  v_cvt_pk_bf16_f32 v10, v6, v7
  ds_write_b32 v158, v10
  v_add_f32_dpp v9, v9, v9 quad_perm:[1,0,3,2] row_mask:0xf bank_mask:0xf
  s_nop 1
  v_add_f32_dpp v9, v9, v9 quad_perm:[2,3,0,1] row_mask:0xf bank_mask:0xf
  v_mov_b32 v6, v9
  s_nop 1
  v_permlane16_swap_b32 v9, v6
  v_add_f32 v9, v9, v6
  v_mov_b32 v6, v9
  s_nop 1
  v_permlane32_swap_b32 v9, v6
  v_add_f32 v9, v9, v6
  ds_write_b64 v160, v[8:9]
  s_sub_u32 s40, s39, 4
  s_cmp_ge_u32 s40, 2
  s_cbranch_scc1 L_40
  s_waitcnt vmcnt(1)
  s_branch L_41
L_40:
  s_waitcnt vmcnt(0)
L_41:
  s_waitcnt lgkmcnt(0)
  s_barrier
  ds_read_b128 v[20:23], v159
  ds_read_b64 v[168:169], v161
  ds_read_b64_tr_b16 v[34:35], v157 offset:4096
  ds_read_b64_tr_b16 v[38:39], v157 offset:12288
  ds_read_b64_tr_b16 v[42:43], v157 offset:20480
  ds_read_b64_tr_b16 v[46:47], v157 offset:28672
  ds_read_b128 v[24:27], v159 offset:1024
  ds_read_b64_tr_b16 v[50:51], v157 offset:36864
  ds_read_b64_tr_b16 v[54:55], v157 offset:45056
  ds_read_b64_tr_b16 v[58:59], v157 offset:53248
  ds_read_b64_tr_b16 v[62:63], v157 offset:61440
  s_waitcnt lgkmcnt(8)
  v_mfma_f32_16x16x32_bf16 v[64:67], v[20:23], v[32:35], 0
  v_max_f32_dpp v170, v168, v168 quad_perm:[1,0,3,2] row_mask:0xf bank_mask:0xf
  s_nop 0
  s_waitcnt lgkmcnt(7)
  v_mfma_f32_16x16x32_bf16 v[68:71], v[20:23], v[36:39], 0
  v_max_f32_dpp v170, v170, v170 quad_perm:[2,3,0,1] row_mask:0xf bank_mask:0xf
  s_nop 0
  s_waitcnt lgkmcnt(6)
  v_mfma_f32_16x16x32_bf16 v[72:75], v[20:23], v[40:43], 0
  v_max_f32_dpp v170, v170, v170 row_half_mirror row_mask:0xf bank_mask:0xf
  v_sub_f32 v168, v168, v170
  v_exp_f32 v168, v168
  s_waitcnt lgkmcnt(5)
  v_mfma_f32_16x16x32_bf16 v[76:79], v[20:23], v[44:47], 0
  v_mul_f32 v169, v168, v169
  s_nop 0
  s_waitcnt lgkmcnt(3)
  v_mfma_f32_16x16x32_bf16 v[80:83], v[24:27], v[48:51], 0
  v_add_f32_dpp v169, v169, v169 quad_perm:[1,0,3,2] row_mask:0xf bank_mask:0xf
  s_nop 0
  s_waitcnt lgkmcnt(2)
  v_mfma_f32_16x16x32_bf16 v[84:87], v[24:27], v[52:55], 0
  v_add_f32_dpp v169, v169, v169 quad_perm:[2,3,0,1] row_mask:0xf bank_mask:0xf
  s_nop 0
  s_waitcnt lgkmcnt(1)
  v_mfma_f32_16x16x32_bf16 v[88:91], v[24:27], v[56:59], 0
  v_add_f32_dpp v169, v169, v169 row_half_mirror row_mask:0xf bank_mask:0xf
  v_rcp_f32 v171, v169
  v_log_f32 v169, v169
  s_waitcnt lgkmcnt(0)
  v_mfma_f32_16x16x32_bf16 v[92:95], v[24:27], v[60:63], 0
  v_mul_f32 v168, v168, v171
  v_add_f32 v170, v170, v169
  s_nop 0
  v_mul_f32_dpp v6, v168, v64 row_newbcast:0 row_mask:0xf bank_mask:0xf
  v_mul_f32_dpp v7, v168, v69 row_newbcast:1 row_mask:0xf bank_mask:0xf
  v_fmac_f32_dpp v6, v168, v74 row_newbcast:2 row_mask:0xf bank_mask:0xf
  v_fmac_f32_dpp v7, v168, v79 row_newbcast:3 row_mask:0xf bank_mask:0xf
  v_fmac_f32_dpp v6, v168, v80 row_newbcast:4 row_mask:0xf bank_mask:0xf
  v_fmac_f32_dpp v7, v168, v85 row_newbcast:5 row_mask:0xf bank_mask:0xf
  v_fmac_f32_dpp v6, v168, v90 row_newbcast:6 row_mask:0xf bank_mask:0xf
  v_fmac_f32_dpp v7, v168, v95 row_newbcast:7 row_mask:0xf bank_mask:0xf
  v_add_f32 v6, v6, v7
  s_nop 1
  v_mov_b32_dpp v7, v6 quad_perm:[1,1,3,3] row_mask:0xf bank_mask:0xf
  v_cvt_pk_bf16_f32 v6, v6, v7
  v_cndmask_b32 v6, v6, v170, s[58:59]
  v_min_u32 v6, -2, v6
  s_mov_b32 exec_lo, s57
  s_mov_b32 exec_hi, s57
  buffer_store_dword v6, v162, s[44:47], s6 offen
  s_barrier
  s_mov_b32 exec_lo, s57
  s_mov_b32 exec_hi, s57
  buffer_store_dword v6, v162, s[44:47], s7 offen sc1
  s_mov_b64 exec, -1
  s_sub_u32 s40, s39, 6
  s_cmp_ge_u32 s40, 2
  s_cbranch_scc1 L_42
  global_load_dword v31, v166, s[8:9]
L_42:
L_done:
L_abort:
L_end:
  s_endpgm
.section .rodata,"a"
.p2align 6
.amdhsa_kernel adaLN_cond__sliding_block_cached__swiglu_ffn__decode_kernel
  .amdhsa_next_free_vgpr 224
  .amdhsa_next_free_sgpr 102
  .amdhsa_accum_offset 224
  .amdhsa_group_segment_fixed_size 0
  .amdhsa_kernarg_size 112
  .amdhsa_user_sgpr_count 2
  .amdhsa_user_sgpr_kernarg_segment_ptr 1
  .amdhsa_system_sgpr_workgroup_id_x 1
  .amdhsa_float_denorm_mode_32 3
.end_amdhsa_kernel
```
